```python
import torch

def _softmax(x, axis=-1):
    return torch.softmax(x, dim=axis)
def _gelu(x):
    return torch.nn.functional.gelu(x, approximate="tanh")
def _silu(x):
    return torch.nn.functional.silu(x)
def _sigmoid(x):
    return torch.sigmoid(x)
def _layernorm(x, axis=-1, eps=1e-5):
    m = x.mean(dim=axis, keepdim=True)
    v = x.var(dim=axis, keepdim=True, unbiased=False)
    return (x - m) / torch.sqrt(v + eps)
def _scatter_add(tgt, idx, src, axis=0):
    return tgt.clone().index_add_(axis, idx, src)
def _segment_sum(src, seg, n):
    out = torch.zeros((n,) + src.shape[1:], dtype=src.dtype)
    return out.index_add_(0, seg, src)
def _pad(x, pw):
    flat = tuple(v for pair in reversed(pw) for v in pair)
    return torch.nn.functional.pad(x, flat)

kernel_name = 'sequential_preLN__sliding_block_cached__dense_activation_relu__decode'

def setup_inputs():

    _w = (lambda a: (lambda t: t.to(torch.bfloat16) if t.is_floating_point() else t)(torch.as_tensor(a)))
    def _A_setup():
        B, Sq, D = 8, 1, 1024
        Hq, Hkv, Sk, Dh = 32, 4, 4096, 128
        assert Hq % Hkv == 0, (Hq, Hkv)
        return {
            "x": _w((lambda *s: torch.randn(*s, dtype=torch.bfloat16) * 0.05)(B, Sq, D)),
            "k_cache": _w((lambda *s: torch.randn(*s, dtype=torch.bfloat16) * 3.2)(B, Hkv, Sk, Dh)),
            "v_cache": _w((lambda *s: torch.randn(*s, dtype=torch.bfloat16) * 0.4)(B, Hkv, Sk, Dh)),
            "wq": _w((lambda *s: torch.randn(*s, dtype=torch.bfloat16) * 3.2)(D, Hq * Dh) * (D ** -0.5)),
            "wo": _w((lambda *s: torch.randn(*s, dtype=torch.bfloat16) * 0.4)(Hq * Dh, D) * ((Hq * Dh) ** -0.5)),
        }
    _A_in = _A_setup()

    def _B_setup():
        B, S, D, Dff = 8, 1, 1024, 3584
        return {
            "x": _w((lambda *s: torch.randn(*s, dtype=torch.bfloat16) * 0.05)(B, S, D)),
            "w1": _w((lambda *s: torch.randn(*s, dtype=torch.bfloat16) * 0.05)(D, Dff)),
            "w2": _w((lambda *s: torch.randn(*s, dtype=torch.bfloat16) * 0.05)(Dff, D)),
        }
    _B_in = _B_setup()

    return {
        "A_x": _A_in["x"],
        "A_k_cache": _A_in["k_cache"],
        "A_v_cache": _A_in["v_cache"],
        "A_wq": _A_in["wq"],
        "A_wo": _A_in["wo"],
        "B_x": _B_in["x"],
        "B_w1": _B_in["w1"],
        "B_w2": _B_in["w2"],
    }

def reference(A_x, A_k_cache, A_v_cache, A_wq, A_wo, B_x, B_w1, B_w2):
    def _A_ref(x, k_cache, v_cache, wq, wo):
        B, Sq, D = x.shape
        Hq, Dh = 32, 128
        Hkv, Sk = k_cache.shape[1], k_cache.shape[2]
        W = min(4096, max(256, Sk // 4))
        rep = Hq // Hkv
        q = (lambda x, *d: x.permute(*d))((x @ wq).reshape(B, Sq, Hq, Dh), 0, 2, 1, 3)
        k = (lambda x, n, axis: torch.repeat_interleave(x, n, dim=axis))(k_cache[:, :, Sk - W:, :], rep, axis=1)
        v = (lambda x, n, axis: torch.repeat_interleave(x, n, dim=axis))(v_cache[:, :, Sk - W:, :], rep, axis=1)
        scores = torch.einsum("bhqd,bhkd->bhqk", q, k) * (Dh ** -0.5)
        p = _softmax(scores, axis=-1)
        o = torch.einsum("bhqk,bhkd->bhqd", p, v)
        return (lambda x, *d: x.permute(*d))(o, 0, 2, 1, 3).reshape(B, Sq, Hq * Dh) @ wo

    def _B_ref(x, w1, w2):
        h = torch.einsum("bsd,df->bsf", x, w1)
        zero = torch.zeros_like(h)
        h = torch.maximum(h, zero)
        return torch.einsum("bsf,fd->bsd", h, w2)

    x = A_x
    h = x + _A_ref(_layernorm(x, axis=-1), A_k_cache, A_v_cache, A_wq, A_wo)
    h2 = h + _B_ref(_layernorm(h, axis=-1), B_w1, B_w2)
    return h2
```

```asm
; @launch grid=(256,1,1) block=(256,1,1) lds=154624
.amdgcn_target "amdgcn-amd-amdhsa--gfx950"
.text
.globl sequential_preLN__sliding_block_cached__dense_activation_relu__decode_kernel
.p2align 8
.type sequential_preLN__sliding_block_cached__dense_activation_relu__decode_kernel,@function
sequential_preLN__sliding_block_cached__dense_activation_relu__decode_kernel:
    s_load_dwordx16 s[16:31], s[0:1], 0
    s_load_dwordx4 s[32:35], s[0:1], 64
    s_load_dwordx2 s[36:37], s[0:1], 80
    s_cmp_ge_u32 s2, 256
    s_cbranch_scc1 L_end
    v_lshrrev_b32 v7, 6, v0
    v_and_b32 v1, 63, v0
    s_lshr_b32 s5, s2, 3
    s_getpc_b64 s[10:11]
L_begin:
    s_lshl_b32 s9, s5, 8
    v_add_u32 v10, s9, v0
    v_and_b32 v10, 1023, v10
    v_lshlrev_b32 v10, 4, v10
    s_mov_b32 s9, L_end - L_begin - 64
    v_min_u32 v10, s9, v10
    global_load_dwordx4 v[12:15], v10, s[10:11]
    v_readfirstlane_b32 s3, v7
    s_and_b32 s4, s2, 7
    s_and_b32 s7, s5, 15
    s_lshl_b32 s6, s4, 5
    s_add_u32 s6, s6, s5
    v_and_b32 v2, 15, v1
    v_lshrrev_b32 v3, 4, v1
    v_lshrrev_b32 v16, 5, v0
    v_and_b32 v17, 31, v0
    v_lshlrev_b32 v18, 11, v16
    v_lshl_add_u32 v18, v17, 4, v18
    s_lshr_b32 s9, s6, 6
    v_lshrrev_b32 v20, 3, v1
    v_and_b32 v19, 7, v1
    v_bfe_u32 v21, v1, 4, 1
    v_lshlrev_b32 v21, 1, v21
    v_xor_b32 v21, v19, v21
    v_lshlrev_b32 v21, 4, v21
    v_lshl_add_u32 v4, v20, 13, v21
    v_xor_b32 v5, 64, v4
    s_lshl_b32 s12, s9, 2
    s_add_u32 s12, s12, s3
    s_lshl_b32 s12, s12, 19
    s_and_b32 s13, s6, 63
    s_lshl_b32 s13, s13, 7
    s_add_u32 s63, s12, s13
    s_lshl_b32 s64, s3, 13
    s_add_u32 s64, s64, 98304
    s_lshl_b32 s13, s9, 9
    s_add_u32 s14, s13, 512
    s_and_b32 s14, s14, 0x600
    s_xor_b32 s12, s13, 1024
    s_xor_b32 s9, s14, 1024
    s_waitcnt lgkmcnt(0)
    s_mov_b32 s40, s16
    s_mov_b32 s41, s17
    s_mov_b32 s42, 16384
    s_mov_b32 s43, 0x20000
    buffer_load_dwordx4 v[192:195], v18, s[40:43], s13 offen
    buffer_load_dwordx4 v[196:199], v18, s[40:43], s14 offen
    buffer_load_dwordx4 v[200:203], v18, s[40:43], s12 offen
    buffer_load_dwordx4 v[204:207], v18, s[40:43], s9 offen
    s_mov_b32 s44, s22
    s_mov_b32 s45, s23
    s_mov_b32 s46, 8388608
    s_mov_b32 s47, 0x20000
    s_load_dword s8, s[36:37], 0
    s_mov_b32 m0, s64
    s_nop 0
    buffer_load_dwordx4 v4, s[44:47], s63 offen offset:0 nt lds
    s_add_u32 s15, s63, 64512
    buffer_load_dwordx4 v5, s[44:47], s15 offen offset:1024 nt lds
    s_add_u32 s15, s63, 129024
    buffer_load_dwordx4 v4, s[44:47], s15 offen offset:2048 nt lds
    s_add_u32 s15, s63, 193536
    buffer_load_dwordx4 v5, s[44:47], s15 offen offset:3072 nt lds
    s_add_u32 s63, s63, 262144
    s_add_u32 s64, s64, 4096
    s_mov_b32 m0, s64
    s_nop 0
    buffer_load_dwordx4 v4, s[44:47], s63 offen offset:0 nt lds
    s_add_u32 s15, s63, 64512
    buffer_load_dwordx4 v5, s[44:47], s15 offen offset:1024 nt lds
    s_add_u32 s15, s63, 129024
    buffer_load_dwordx4 v4, s[44:47], s15 offen offset:2048 nt lds
    s_add_u32 s15, s63, 193536
    buffer_load_dwordx4 v5, s[44:47], s15 offen offset:3072 nt lds
    s_add_u32 s63, s63, 262144
    s_add_u32 s64, s64, 4096
    s_mov_b32 s38, 268435456
    s_mov_b32 s39, 0x20000
    s_mov_b32 s48, s18
    s_mov_b32 s49, s19
    s_mov_b32 s50, 33554432
    s_mov_b32 s51, 0x20000
    s_mov_b32 s52, 0x07060501
    s_mov_b32 s53, 0x07060502
    s_mov_b32 s54, 0x07060503
    s_mov_b32 s55, 0x0C04000C
    s_mov_b32 s56, 0x0402010C
    v_mul_u32_u24 v22, 544, v16
    v_lshl_add_u32 v29, v17, 4, v22
    v_add_u32 v29, 131072, v29
    v_mul_u32_u24 v22, 544, v19
    v_lshl_add_u32 v8, v3, 4, v22
    v_add_u32 v8, 131072, v8
    v_bfe_u32 v23, v1, 2, 2
    v_and_b32 v24, 3, v1
    v_lshlrev_b32 v24, 3, v24
    v_and_b32 v25, 1, v3
    v_lshl_add_u32 v26, v3, 3, v23
    v_lshrrev_b32 v27, 1, v23
    v_lshl_add_u32 v27, v25, 1, v27
    v_xor_b32 v27, s3, v27
    v_lshl_add_u32 v27, v27, 5, v24
    v_lshl_add_u32 v6, v26, 7, v27
    v_add_u32 v7, 0x10000, v6
    v_lshlrev_b32 v9, 4, v0
    s_lshl_b32 s13, s3, 6
    v_lshlrev_b32 v27, 9, v2
    v_lshl_add_u32 v28, v3, 4, v27
    v_add_u32 v28, s13, v28
    v_xor_b32 v27, v2, v3
    v_lshlrev_b32 v27, 4, v27
    v_lshl_add_u32 v240, v3, 8, v27
    v_xor_b32 v241, 64, v240
    v_xor_b32 v242, 128, v240
    v_xor_b32 v243, 192, v240
    s_lshl_b32 s68, s4, 4
    s_add_u32 s68, s68, s7
    s_lshr_b32 s12, s68, 2
    s_lshl_b32 s12, s12, 20
    s_and_b32 s13, s68, 3
    s_lshl_b32 s13, s13, 16
    s_add_u32 s12, s12, s13
    s_lshl_b32 s62, s3, 14
    s_add_u32 s12, s12, s62
    s_add_u32 s66, s12, 0xC0000
    s_mov_b32 s63, s66
    s_mov_b32 s64, s62
    s_lshl_b32 s9, s6, 12
    s_add_u32 s9, s9, 1048576
    s_waitcnt lgkmcnt(0)
    s_mul_i32 s8, s8, 0x9E3779B1
    s_add_u32 s8, s8, 0x7F4A7C15
    s_waitcnt vmcnt(8)
    v_lshlrev_b32 v96, 16, v192
    v_and_b32 v97, 0xffff0000, v192
    v_lshlrev_b32 v98, 16, v193
    v_and_b32 v99, 0xffff0000, v193
    v_lshlrev_b32 v100, 16, v194
    v_and_b32 v101, 0xffff0000, v194
    v_lshlrev_b32 v102, 16, v195
    v_and_b32 v103, 0xffff0000, v195
    v_lshlrev_b32 v104, 16, v196
    v_and_b32 v105, 0xffff0000, v196
    v_lshlrev_b32 v106, 16, v197
    v_and_b32 v107, 0xffff0000, v197
    v_lshlrev_b32 v108, 16, v198
    v_and_b32 v109, 0xffff0000, v198
    v_lshlrev_b32 v110, 16, v199
    v_and_b32 v111, 0xffff0000, v199
    v_lshlrev_b32 v112, 16, v200
    v_and_b32 v113, 0xffff0000, v200
    v_lshlrev_b32 v114, 16, v201
    v_and_b32 v115, 0xffff0000, v201
    v_lshlrev_b32 v116, 16, v202
    v_and_b32 v117, 0xffff0000, v202
    v_lshlrev_b32 v118, 16, v203
    v_and_b32 v119, 0xffff0000, v203
    v_lshlrev_b32 v120, 16, v204
    v_and_b32 v121, 0xffff0000, v204
    v_lshlrev_b32 v122, 16, v205
    v_and_b32 v123, 0xffff0000, v205
    v_lshlrev_b32 v124, 16, v206
    v_and_b32 v125, 0xffff0000, v206
    v_lshlrev_b32 v126, 16, v207
    v_and_b32 v127, 0xffff0000, v207
    v_pk_add_f32 v[40:41], v[96:97], v[98:99]
    v_pk_add_f32 v[42:43], v[100:101], v[102:103]
    v_pk_add_f32 v[40:41], v[40:41], v[104:105]
    v_pk_add_f32 v[42:43], v[42:43], v[106:107]
    v_pk_add_f32 v[40:41], v[40:41], v[108:109]
    v_pk_add_f32 v[42:43], v[42:43], v[110:111]
    v_pk_add_f32 v[40:41], v[40:41], v[112:113]
    v_pk_add_f32 v[42:43], v[42:43], v[114:115]
    v_pk_add_f32 v[40:41], v[40:41], v[116:117]
    v_pk_add_f32 v[42:43], v[42:43], v[118:119]
    v_pk_add_f32 v[40:41], v[40:41], v[120:121]
    v_pk_add_f32 v[42:43], v[42:43], v[122:123]
    v_pk_add_f32 v[40:41], v[40:41], v[124:125]
    v_pk_add_f32 v[42:43], v[42:43], v[126:127]
    v_pk_add_f32 v[40:41], v[40:41], v[42:43]
    v_add_f32 v40, v40, v41
    s_nop 1
    v_add_f32_dpp v40, v40, v40 row_ror:8 row_mask:0xf bank_mask:0xf
    s_nop 1
    v_add_f32_dpp v40, v40, v40 row_ror:4 row_mask:0xf bank_mask:0xf
    s_nop 1
    v_add_f32_dpp v40, v40, v40 row_ror:2 row_mask:0xf bank_mask:0xf
    s_nop 1
    v_add_f32_dpp v40, v40, v40 row_ror:1 row_mask:0xf bank_mask:0xf
    v_mov_b32 v11, v40
    s_nop 1
    v_permlane16_swap_b32 v40, v11
    s_nop 0
    v_add_f32 v40, v40, v11
    v_mul_f32 v40, 0xba800000, v40
    v_mov_b32 v41, v40
    v_pk_add_f32 v[64:65], v[96:97], v[40:41]
    v_pk_mul_f32 v[44:45], v[64:65], v[64:65]
    v_pk_add_f32 v[66:67], v[98:99], v[40:41]
    v_pk_mul_f32 v[46:47], v[66:67], v[66:67]
    v_pk_add_f32 v[68:69], v[100:101], v[40:41]
    v_pk_fma_f32 v[44:45], v[68:69], v[68:69], v[44:45]
    v_pk_add_f32 v[70:71], v[102:103], v[40:41]
    v_pk_fma_f32 v[46:47], v[70:71], v[70:71], v[46:47]
    v_pk_add_f32 v[72:73], v[104:105], v[40:41]
    v_pk_fma_f32 v[44:45], v[72:73], v[72:73], v[44:45]
    v_pk_add_f32 v[74:75], v[106:107], v[40:41]
    v_pk_fma_f32 v[46:47], v[74:75], v[74:75], v[46:47]
    v_pk_add_f32 v[76:77], v[108:109], v[40:41]
    v_pk_fma_f32 v[44:45], v[76:77], v[76:77], v[44:45]
    v_pk_add_f32 v[78:79], v[110:111], v[40:41]
    v_pk_fma_f32 v[46:47], v[78:79], v[78:79], v[46:47]
    v_pk_add_f32 v[64:65], v[112:113], v[40:41]
    v_pk_fma_f32 v[44:45], v[64:65], v[64:65], v[44:45]
    v_pk_add_f32 v[66:67], v[114:115], v[40:41]
    v_pk_fma_f32 v[46:47], v[66:67], v[66:67], v[46:47]
    v_pk_add_f32 v[68:69], v[116:117], v[40:41]
    v_pk_fma_f32 v[44:45], v[68:69], v[68:69], v[44:45]
    v_pk_add_f32 v[70:71], v[118:119], v[40:41]
    v_pk_fma_f32 v[46:47], v[70:71], v[70:71], v[46:47]
    v_pk_add_f32 v[72:73], v[120:121], v[40:41]
    v_pk_fma_f32 v[44:45], v[72:73], v[72:73], v[44:45]
    v_pk_add_f32 v[74:75], v[122:123], v[40:41]
    v_pk_fma_f32 v[46:47], v[74:75], v[74:75], v[46:47]
    v_pk_add_f32 v[76:77], v[124:125], v[40:41]
    v_pk_fma_f32 v[44:45], v[76:77], v[76:77], v[44:45]
    v_pk_add_f32 v[78:79], v[126:127], v[40:41]
    v_pk_fma_f32 v[46:47], v[78:79], v[78:79], v[46:47]
    v_pk_add_f32 v[44:45], v[44:45], v[46:47]
    v_add_f32 v44, v44, v45
    s_nop 1
    v_add_f32_dpp v44, v44, v44 row_ror:8 row_mask:0xf bank_mask:0xf
    s_nop 1
    v_add_f32_dpp v44, v44, v44 row_ror:4 row_mask:0xf bank_mask:0xf
    s_nop 1
    v_add_f32_dpp v44, v44, v44 row_ror:2 row_mask:0xf bank_mask:0xf
    s_nop 1
    v_add_f32_dpp v44, v44, v44 row_ror:1 row_mask:0xf bank_mask:0xf
    v_mov_b32 v11, v44
    s_nop 1
    v_permlane16_swap_b32 v44, v11
    s_nop 0
    v_add_f32 v44, v44, v11
    v_mul_f32 v44, 0x3a800000, v44
    v_cvt_pk_bf16_f32 v40, v40, v40
    v_lshlrev_b32 v40, 16, v40
    v_cvt_pk_bf16_f32 v44, v44, v44
    v_lshlrev_b32 v44, 16, v44
    v_add_f32 v44, 0x3727c5ac, v44
    v_cvt_pk_bf16_f32 v44, v44, v44
    v_lshlrev_b32 v44, 16, v44
    v_sqrt_f32 v44, v44
    v_mov_b32 v41, v40
    v_pk_add_f32 v[96:97], v[96:97], v[40:41]
    v_pk_add_f32 v[98:99], v[98:99], v[40:41]
    v_pk_add_f32 v[100:101], v[100:101], v[40:41]
    v_pk_add_f32 v[102:103], v[102:103], v[40:41]
    v_cvt_pk_bf16_f32 v44, v44, v44
    v_lshlrev_b32 v44, 16, v44
    v_rcp_f32 v46, v44
    v_sub_f32 v44, 0, v44
    v_mov_b32 v45, v44
    v_cvt_pk_bf16_f32 v48, v96, v97
    v_cvt_pk_bf16_f32 v49, v98, v99
    v_cvt_pk_bf16_f32 v50, v100, v101
    v_cvt_pk_bf16_f32 v51, v102, v103
    v_mov_b32 v47, v46
    v_lshlrev_b32 v96, 16, v48
    v_and_b32 v97, 0xffff0000, v48
    v_lshlrev_b32 v98, 16, v49
    v_and_b32 v99, 0xffff0000, v49
    v_lshlrev_b32 v100, 16, v50
    v_and_b32 v101, 0xffff0000, v50
    v_lshlrev_b32 v102, 16, v51
    v_and_b32 v103, 0xffff0000, v51
    v_pk_mul_f32 v[112:113], v[96:97], v[46:47]
    v_pk_mul_f32 v[114:115], v[98:99], v[46:47]
    v_pk_mul_f32 v[116:117], v[100:101], v[46:47]
    v_pk_mul_f32 v[118:119], v[102:103], v[46:47]
    v_pk_fma_f32 v[96:97], v[112:113], v[44:45], v[96:97]
    v_pk_fma_f32 v[98:99], v[114:115], v[44:45], v[98:99]
    v_pk_fma_f32 v[100:101], v[116:117], v[44:45], v[100:101]
    v_pk_fma_f32 v[102:103], v[118:119], v[44:45], v[102:103]
    v_pk_fma_f32 v[112:113], v[96:97], v[46:47], v[112:113]
    v_pk_fma_f32 v[114:115], v[98:99], v[46:47], v[114:115]
    v_pk_fma_f32 v[116:117], v[100:101], v[46:47], v[116:117]
    v_pk_fma_f32 v[118:119], v[102:103], v[46:47], v[118:119]
    v_cvt_pk_bf16_f32 v48, v112, v113
    v_cvt_pk_bf16_f32 v49, v114, v115
    v_cvt_pk_bf16_f32 v50, v116, v117
    v_cvt_pk_bf16_f32 v51, v118, v119
    ds_write_b128 v29, v[48:51]
    v_mov_b32 v14, s8
    v_mov_b32 v15, s8
    v_mov_b32 v42, s8
    v_mov_b32 v43, s8
    s_cmp_lt_u32 s5, 16
    s_cbranch_scc1 L_nok
    s_mov_b32 m0, s64
    s_waitcnt vmcnt(5)
    buffer_load_dwordx4 v240, s[48:51], s63 offen offset:0 nt lds
    s_waitcnt vmcnt(5)
    buffer_load_dwordx4 v241, s[48:51], s63 offen offset:1024 nt lds
    s_waitcnt vmcnt(5)
    buffer_load_dwordx4 v242, s[48:51], s63 offen offset:2048 nt lds
    s_waitcnt vmcnt(5)
    buffer_load_dwordx4 v243, s[48:51], s63 offen offset:3072 nt lds
    s_add_u32 s63, s63, 4096
    s_add_u32 s64, s64, 4096
    s_mov_b32 m0, s64
    s_waitcnt vmcnt(5)
    buffer_load_dwordx4 v240, s[48:51], s63 offen offset:0 nt lds
    s_waitcnt vmcnt(5)
    buffer_load_dwordx4 v241, s[48:51], s63 offen offset:1024 nt lds
    s_waitcnt vmcnt(6)
    buffer_load_dwordx4 v242, s[48:51], s63 offen offset:2048 nt lds
    s_waitcnt vmcnt(7)
    buffer_load_dwordx4 v243, s[48:51], s63 offen offset:3072 nt lds
    s_add_u32 s63, s63, 4096
    s_add_u32 s64, s64, 4096
    s_waitcnt vmcnt(8) lgkmcnt(0)
    s_branch L_qb
L_nok:
    s_waitcnt vmcnt(0) lgkmcnt(0)
L_qb:
    s_barrier
    ds_read_b128 v[192:195], v8 offset:0
    ds_read_b64_tr_b16 v[64:65], v7 offset:32768
    ds_read_b64_tr_b16 v[66:67], v7 offset:33280
    ds_read_b128 v[196:199], v8 offset:64
    ds_read_b64_tr_b16 v[68:69], v7 offset:36864
    ds_read_b64_tr_b16 v[70:71], v7 offset:37376
    ds_read_b128 v[200:203], v8 offset:128
    ds_read_b64_tr_b16 v[72:73], v7 offset:40960
    ds_read_b64_tr_b16 v[74:75], v7 offset:41472
    ds_read_b128 v[204:207], v8 offset:192
    ds_read_b64_tr_b16 v[76:77], v7 offset:45056
    ds_read_b64_tr_b16 v[78:79], v7 offset:45568
    ds_read_b128 v[208:211], v8 offset:256
    ds_read_b64_tr_b16 v[80:81], v7 offset:49152
    ds_read_b64_tr_b16 v[82:83], v7 offset:49664
    s_waitcnt lgkmcnt(12)
    v_mfma_f32_16x16x32_bf16 v[32:35], v[64:67], v[192:195], 0
    ds_read_b128 v[212:215], v8 offset:320
    ds_read_b64_tr_b16 v[84:85], v7 offset:53248
    ds_read_b64_tr_b16 v[86:87], v7 offset:53760
    s_waitcnt lgkmcnt(12)
    v_mfma_f32_16x16x32_bf16 v[32:35], v[68:71], v[196:199], v[32:35]
    ds_read_b128 v[216:219], v8 offset:384
    ds_read_b64_tr_b16 v[88:89], v7 offset:57344
    ds_read_b64_tr_b16 v[90:91], v7 offset:57856
    s_waitcnt lgkmcnt(12)
    v_mfma_f32_16x16x32_bf16 v[32:35], v[72:75], v[200:203], v[32:35]
    ds_read_b128 v[220:223], v8 offset:448
    ds_read_b64_tr_b16 v[92:93], v7 offset:61440
    ds_read_b64_tr_b16 v[94:95], v7 offset:61952
    s_waitcnt lgkmcnt(12)
    v_mfma_f32_16x16x32_bf16 v[32:35], v[76:79], v[204:207], v[32:35]
    s_waitcnt lgkmcnt(9)
    v_mfma_f32_16x16x32_bf16 v[32:35], v[80:83], v[208:211], v[32:35]
    s_waitcnt lgkmcnt(6)
    v_mfma_f32_16x16x32_bf16 v[32:35], v[84:87], v[212:215], v[32:35]
    s_waitcnt lgkmcnt(3)
    v_mfma_f32_16x16x32_bf16 v[32:35], v[88:91], v[216:219], v[32:35]
    s_waitcnt lgkmcnt(0)
    v_mfma_f32_16x16x32_bf16 v[32:35], v[92:95], v[220:223], v[32:35]
    s_mov_b32 exec_lo, 0xff00ff
    s_mov_b32 exec_hi, 0xff00ff
    s_nop 5
    v_add_u32 v32, 0x80, v32
    v_add_u32 v33, 0x80, v33
    v_add_u32 v34, 0x80, v34
    v_add_u32 v35, 0x80, v35
    v_perm_b32 v12, v32, v35, s52
    v_perm_b32 v13, v33, v35, s53
    v_perm_b32 v14, v34, v35, s54
    buffer_store_dwordx4 v[12:15], v28, s[36:39], s9 offen sc1
    s_mov_b64 exec, -1
    s_cmp_eq_u32 s5, 15
    s_cbranch_scc1 L_done
    s_barrier
    s_cmp_ge_u32 s5, 16
    s_cbranch_scc1 L_attn
    s_lshl_b32 s64, s3, 15
    s_cmp_ge_u32 s5, 8
    s_cbranch_scc1 L_f1
    s_lshr_b32 s12, s7, 1
    s_lshl_b32 s11, s4, 2
    s_add_u32 s12, s12, s11
    s_and_b32 s13, s7, 1
    v_xor_b32 v240, 0, v1
    v_xor_b32 v241, 2, v1
    v_xor_b32 v242, 4, v1
    v_xor_b32 v243, 6, v1
    v_lshlrev_b32 v240, 4, v240
    v_lshlrev_b32 v241, 4, v241
    v_lshlrev_b32 v242, 4, v242
    v_lshlrev_b32 v243, 4, v243
    s_mov_b32 s44, s24
    s_mov_b32 s45, s25
    s_mov_b32 s46, 8388608
    s_mov_b32 s47, 0x20000
    s_lshl_b32 s6, s4, 3
    s_add_u32 s6, s6, s7
    s_lshl_b32 s14, s6, 2
    s_add_u32 s14, s14, s3
    v_lshlrev_b32 v62, 11, v19
    s_lshl_b32 s68, s14, 3
    buffer_load_dwordx2 v[60:61], v62, s[40:43], s68 offen
    s_lshl_b32 s10, s12, 2
    s_add_u32 s10, s10, s3
    s_lshl_b32 s10, s10, 16
    s_lshl_b32 s11, s13, 10
    s_add_u32 s63, s10, s11
    s_mov_b32 m0, s64
    s_waitcnt vmcnt(1)
    buffer_load_dwordx4 v240, s[44:47], s63 offen offset:0 nt lds
    s_waitcnt vmcnt(1)
    s_add_u32 s15, s63, 1024
    buffer_load_dwordx4 v241, s[44:47], s15 offen offset:1024 nt lds
    s_waitcnt vmcnt(1)
    s_add_u32 s15, s63, 2048
    buffer_load_dwordx4 v242, s[44:47], s15 offen offset:2048 nt lds
    s_waitcnt vmcnt(1)
    s_add_u32 s15, s63, 3072
    buffer_load_dwordx4 v243, s[44:47], s15 offen offset:3072 nt lds
    s_add_u32 s63, s63, 8192
    s_add_u32 s64, s64, 4096
    s_mov_b32 m0, s64
    s_waitcnt vmcnt(9)
    buffer_load_dwordx4 v240, s[44:47], s63 offen offset:0 nt lds
    s_waitcnt vmcnt(9)
    s_add_u32 s15, s63, 1024
    buffer_load_dwordx4 v241, s[44:47], s15 offen offset:1024 nt lds
    s_waitcnt vmcnt(9)
    s_add_u32 s15, s63, 2048
    buffer_load_dwordx4 v242, s[44:47], s15 offen offset:2048 nt lds
    s_waitcnt vmcnt(9)
    s_add_u32 s15, s63, 3072
    buffer_load_dwordx4 v243, s[44:47], s15 offen offset:3072 nt lds
    s_add_u32 s63, s63, 8192
    s_add_u32 s64, s64, 4096
    s_mov_b32 s65, 1
L_dl_1:
    v_xor_b32 v240, 128, v240
    v_xor_b32 v241, 128, v241
    v_xor_b32 v242, 128, v242
    v_xor_b32 v243, 128, v243
    s_mov_b32 m0, s64
    s_waitcnt vmcnt(9)
    buffer_load_dwordx4 v240, s[44:47], s63 offen offset:0 nt lds
    s_waitcnt vmcnt(9)
    s_add_u32 s15, s63, 1024
    buffer_load_dwordx4 v241, s[44:47], s15 offen offset:1024 nt lds
    s_waitcnt vmcnt(9)
    s_add_u32 s15, s63, 2048
    buffer_load_dwordx4 v242, s[44:47], s15 offen offset:2048 nt lds
    s_waitcnt vmcnt(9)
    s_add_u32 s15, s63, 3072
    buffer_load_dwordx4 v243, s[44:47], s15 offen offset:3072 nt lds
    s_add_u32 s63, s63, 8192
    s_add_u32 s64, s64, 4096
    s_mov_b32 m0, s64
    s_waitcnt vmcnt(9)
    buffer_load_dwordx4 v240, s[44:47], s63 offen offset:0 nt lds
    s_waitcnt vmcnt(9)
    s_add_u32 s15, s63, 1024
    buffer_load_dwordx4 v241, s[44:47], s15 offen offset:1024 nt lds
    s_waitcnt vmcnt(9)
    s_add_u32 s15, s63, 2048
    buffer_load_dwordx4 v242, s[44:47], s15 offen offset:2048 nt lds
    s_waitcnt vmcnt(9)
    s_add_u32 s15, s63, 3072
    buffer_load_dwordx4 v243, s[44:47], s15 offen offset:3072 nt lds
    s_add_u32 s63, s63, 8192
    s_add_u32 s64, s64, 4096
    s_add_u32 s65, s65, 1
    s_cmp_lt_u32 s65, 4
    s_cbranch_scc1 L_dl_1
    v_lshl_add_u32 v22, v25, 2, v23
    v_lshl_add_u32 v22, v22, 5, v24
    s_lshl_b32 s11, s3, 8
    v_lshl_add_u32 v6, v26, 10, v22
    v_add_u32 v6, s11, v6
    v_mul_u32_u24 v22, 288, v16
    v_lshl_add_u32 v29, v17, 3, v22
    v_add_u32 v29, 131072, v29
    v_mul_u32_u24 v22, 288, v19
    v_lshl_add_u32 v8, v3, 4, v22
    v_add_u32 v8, 131072, v8
    s_lshl_b32 s11, s3, 3
    v_lshrrev_b32 v22, 3, v2
    v_add_u32 v22, s11, v22
    v_lshl_add_u32 v22, v22, 2, v3
    v_lshlrev_b32 v22, 12, v22
    v_lshl_add_u32 v28, v19, 4, v22
    v_lshlrev_b32 v22, 16, v16
    v_lshl_add_u32 v18, v17, 4, v22
    v_lshlrev_b32 v22, 11, v16
    v_lshl_add_u32 v27, v24, 4, v22
    v_cmp_lt_u32 s[66:67], 7, v2
    v_mov_b32 v47, s8
    v_mov_b32 v50, s8
    v_mov_b32 v51, s8
    v_mov_b32 v54, s8
    v_mov_b32 v55, s8
    v_lshlrev_b32 v63, 4, v1
    s_lshl_b32 s10, s3, 6
    v_lshl_add_u32 v31, v19, 3, s10
    v_add_u32 v31, 147712, v31
    s_lshr_b32 s10, s12, 3
    s_and_b32 s11, s12, 7
    s_lshl_b32 s58, s10, 14
    s_lshl_b32 s9, s11, 9
    s_add_u32 s58, s58, s9
    s_add_u32 s58, s58, 2097152
    s_add_u32 s59, s58, 4096
    s_add_u32 s60, s58, 8192
    s_add_u32 s61, s58, 12288
    s_lshl_b32 s10, s10, 9
    s_lshl_b32 s11, s11, 4
    s_add_u32 s11, s11, s10
    s_add_u32 s11, s11, 2621440
    s_lshl_b32 s9, s13, 19
    s_lshl_b32 s10, s12, 7
    s_add_u32 s9, s9, s10
    s_add_u32 s9, s9, 5242880
    s_add_u32 s10, s9, 32768
    s_add_u32 s12, s9, 65536
    s_add_u32 s13, s9, 98304
    v_and_b32 v40, 15, v1
    v_lshlrev_b32 v40, 4, v40
    s_lshl_b32 s15, s4, 8
    s_add_u32 s15, s15, 3014656
    buffer_load_dword v41, v40, s[36:39], s15 offen sc1
    s_waitcnt vmcnt(0)
    s_barrier
    v_cmp_ne_u32 vcc, s8, v41
    s_cbranch_vccnz L_st_2
    buffer_load_dwordx4 v[208:211], v27, s[36:39], s11 offen sc1
    buffer_load_dwordx4 v[192:195], v18, s[36:39], s58 offen sc1
    buffer_load_dwordx4 v[196:199], v18, s[36:39], s59 offen sc1
    buffer_load_dwordx4 v[200:203], v18, s[36:39], s60 offen sc1
    buffer_load_dwordx4 v[204:207], v18, s[36:39], s61 offen sc1
L_st_2:
    s_mov_b64 s[0:1], vcc
    v_xor_b32 v12, 0, v6
    v_add_u32 v13, 0x10000, v12
    ds_read_b64_tr_b16 v[64:65], v12 offset:0
    ds_read_b64_tr_b16 v[66:67], v12 offset:4096
    ds_read_b64_tr_b16 v[68:69], v12 offset:32768
    ds_read_b64_tr_b16 v[70:71], v12 offset:36864
    ds_read_b64_tr_b16 v[72:73], v13 offset:0
    ds_read_b64_tr_b16 v[74:75], v13 offset:4096
    ds_read_b64_tr_b16 v[76:77], v13 offset:32768
    ds_read_b64_tr_b16 v[78:79], v13 offset:36864
    v_xor_b32 v14, 32, v6
    v_add_u32 v15, 0x10000, v14
    ds_read_b64_tr_b16 v[80:81], v14 offset:0
    ds_read_b64_tr_b16 v[82:83], v14 offset:4096
    ds_read_b64_tr_b16 v[84:85], v14 offset:32768
    ds_read_b64_tr_b16 v[86:87], v14 offset:36864
    ds_read_b64_tr_b16 v[88:89], v15 offset:0
    ds_read_b64_tr_b16 v[90:91], v15 offset:4096
    ds_read_b64_tr_b16 v[92:93], v15 offset:32768
    ds_read_b64_tr_b16 v[94:95], v15 offset:36864
    v_xor_b32 v12, 64, v6
    v_add_u32 v13, 0x10000, v12
    ds_read_b64_tr_b16 v[96:97], v12 offset:0
    ds_read_b64_tr_b16 v[98:99], v12 offset:4096
    ds_read_b64_tr_b16 v[100:101], v12 offset:32768
    ds_read_b64_tr_b16 v[102:103], v12 offset:36864
    ds_read_b64_tr_b16 v[104:105], v13 offset:0
    ds_read_b64_tr_b16 v[106:107], v13 offset:4096
    ds_read_b64_tr_b16 v[108:109], v13 offset:32768
    ds_read_b64_tr_b16 v[110:111], v13 offset:36864
    v_xor_b32 v14, 96, v6
    v_add_u32 v15, 0x10000, v14
    ds_read_b64_tr_b16 v[112:113], v14 offset:0
    ds_read_b64_tr_b16 v[114:115], v14 offset:4096
    ds_read_b64_tr_b16 v[116:117], v14 offset:32768
    ds_read_b64_tr_b16 v[118:119], v14 offset:36864
    ds_read_b64_tr_b16 v[120:121], v15 offset:0
    ds_read_b64_tr_b16 v[122:123], v15 offset:4096
    ds_read_b64_tr_b16 v[124:125], v15 offset:32768
    ds_read_b64_tr_b16 v[126:127], v15 offset:36864
    v_xor_b32 v12, 128, v6
    v_add_u32 v13, 0x10000, v12
    ds_read_b64_tr_b16 v[128:129], v12 offset:0
    ds_read_b64_tr_b16 v[130:131], v12 offset:4096
    ds_read_b64_tr_b16 v[132:133], v12 offset:32768
    ds_read_b64_tr_b16 v[134:135], v12 offset:36864
    ds_read_b64_tr_b16 v[136:137], v13 offset:0
    ds_read_b64_tr_b16 v[138:139], v13 offset:4096
    ds_read_b64_tr_b16 v[140:141], v13 offset:32768
    ds_read_b64_tr_b16 v[142:143], v13 offset:36864
    v_xor_b32 v14, 160, v6
    v_add_u32 v15, 0x10000, v14
    ds_read_b64_tr_b16 v[144:145], v14 offset:0
    ds_read_b64_tr_b16 v[146:147], v14 offset:4096
    ds_read_b64_tr_b16 v[148:149], v14 offset:32768
    ds_read_b64_tr_b16 v[150:151], v14 offset:36864
    ds_read_b64_tr_b16 v[152:153], v15 offset:0
    ds_read_b64_tr_b16 v[154:155], v15 offset:4096
    ds_read_b64_tr_b16 v[156:157], v15 offset:32768
    ds_read_b64_tr_b16 v[158:159], v15 offset:36864
    v_xor_b32 v12, 192, v6
    v_add_u32 v13, 0x10000, v12
    ds_read_b64_tr_b16 v[160:161], v12 offset:0
    ds_read_b64_tr_b16 v[162:163], v12 offset:4096
    ds_read_b64_tr_b16 v[164:165], v12 offset:32768
    ds_read_b64_tr_b16 v[166:167], v12 offset:36864
    ds_read_b64_tr_b16 v[168:169], v13 offset:0
    ds_read_b64_tr_b16 v[170:171], v13 offset:4096
    ds_read_b64_tr_b16 v[172:173], v13 offset:32768
    ds_read_b64_tr_b16 v[174:175], v13 offset:36864
    v_xor_b32 v14, 224, v6
    v_add_u32 v15, 0x10000, v14
    ds_read_b64_tr_b16 v[176:177], v14 offset:0
    ds_read_b64_tr_b16 v[178:179], v14 offset:4096
    ds_read_b64_tr_b16 v[180:181], v14 offset:32768
    ds_read_b64_tr_b16 v[182:183], v14 offset:36864
    ds_read_b64_tr_b16 v[184:185], v15 offset:0
    ds_read_b64_tr_b16 v[186:187], v15 offset:4096
    ds_read_b64_tr_b16 v[188:189], v15 offset:32768
    ds_read_b64_tr_b16 v[190:191], v15 offset:36864
    s_mov_b32 s40, s32
    s_mov_b32 s41, s33
    s_mov_b32 s42, 16384
    s_mov_b32 s43, 0x20000
    v_lshlrev_b32 v56, 16, v60
    v_and_b32 v57, 0xffff0000, v60
    v_lshlrev_b32 v58, 16, v61
    v_and_b32 v59, 0xffff0000, v61
    s_cmp_eq_u64 s[0:1], 0
    s_cbranch_scc1 L_sg_3
    v_and_b32 v40, 15, v1
    v_lshlrev_b32 v40, 4, v40
    s_lshl_b32 s15, s4, 8
    s_add_u32 s15, s15, 3014656
    s_mov_b32 s57, 0
L_hu_4:
    buffer_load_dword v41, v40, s[36:39], s15 offen sc1
    s_add_u32 s57, s57, 1
    s_waitcnt vmcnt(0)
    v_cmp_ne_u32 vcc, s8, v41
    s_cbranch_vccz L_hue_5
    s_cmp_lt_u32 s57, 400
    s_cbranch_scc1 L_hu_4
L_hue_5:
    buffer_load_dwordx4 v[208:211], v27, s[36:39], s11 offen sc1
    buffer_load_dwordx4 v[192:195], v18, s[36:39], s58 offen sc1
    buffer_load_dwordx4 v[196:199], v18, s[36:39], s59 offen sc1
    buffer_load_dwordx4 v[200:203], v18, s[36:39], s60 offen sc1
    buffer_load_dwordx4 v[204:207], v18, s[36:39], s61 offen sc1
L_sg_3:
    s_mov_b32 s57, 0
    s_waitcnt vmcnt(0)
    v_xor_b32 v10, s8, v210
    v_bitop3_b32 v10, v10, v211, s8 bitop3:0xF6
    v_bitop3_b32 v10, v10, v195, s8 bitop3:0xF6
    v_bitop3_b32 v10, v10, v199, s8 bitop3:0xF6
    v_bitop3_b32 v10, v10, v203, s8 bitop3:0xF6
    v_bitop3_b32 v10, v10, v207, s8 bitop3:0xF6
    v_cmp_ne_u32 vcc, 0, v10
    s_cbranch_vccz L_ge_7
L_g_6:
    s_sleep 4
    buffer_load_dwordx4 v[208:211], v27, s[36:39], s11 offen sc1
    buffer_load_dwordx4 v[192:195], v18, s[36:39], s58 offen sc1
    buffer_load_dwordx4 v[196:199], v18, s[36:39], s59 offen sc1
    buffer_load_dwordx4 v[200:203], v18, s[36:39], s60 offen sc1
    buffer_load_dwordx4 v[204:207], v18, s[36:39], s61 offen sc1
    s_add_u32 s57, s57, 1
    s_waitcnt vmcnt(0)
    v_xor_b32 v10, s8, v210
    v_bitop3_b32 v10, v10, v211, s8 bitop3:0xF6
    v_bitop3_b32 v10, v10, v195, s8 bitop3:0xF6
    v_bitop3_b32 v10, v10, v199, s8 bitop3:0xF6
    v_bitop3_b32 v10, v10, v203, s8 bitop3:0xF6
    v_bitop3_b32 v10, v10, v207, s8 bitop3:0xF6
    v_cmp_ne_u32 vcc, 0, v10
    s_cbranch_vccz L_ge_7
    s_cmp_lt_u32 s57, 150000
    s_cbranch_scc1 L_g_6
L_ge_7:
    v_max_f32_dpp v36, v208, v208 quad_perm:[1,0,3,2] row_mask:0xf bank_mask:0xf
    v_perm_b32 v195, v193, v192, s55
    v_perm_b32 v195, v194, v195, s56
    v_max_f32_dpp v36, v36, v36 quad_perm:[2,3,0,1] row_mask:0xf bank_mask:0xf
    v_sub_f32 v37, v208, v36
    v_exp_f32 v37, v37
    v_perm_b32 v199, v197, v196, s55
    v_perm_b32 v199, v198, v199, s56
    v_mul_f32 v38, v37, v209
    v_perm_b32 v203, v201, v200, s55
    v_perm_b32 v203, v202, v203, s56
    v_add_f32_dpp v38, v38, v38 quad_perm:[1,0,3,2] row_mask:0xf bank_mask:0xf
    v_perm_b32 v207, v205, v204, s55
    v_perm_b32 v207, v206, v207, s56
    v_add_f32_dpp v38, v38, v38 quad_perm:[2,3,0,1] row_mask:0xf bank_mask:0xf
    v_mul_f32_dpp v40, v37, v192 quad_perm:[0,0,0,0] row_mask:0xf bank_mask:0xf
    v_mul_f32_dpp v41, v37, v193 quad_perm:[0,0,0,0] row_mask:0xf bank_mask:0xf
    v_mul_f32_dpp v42, v37, v194 quad_perm:[0,0,0,0] row_mask:0xf bank_mask:0xf
    v_mul_f32_dpp v43, v37, v195 quad_perm:[0,0,0,0] row_mask:0xf bank_mask:0xf
    v_rcp_f32 v38, v38
    v_fmac_f32_dpp v40, v37, v196 quad_perm:[1,1,1,1] row_mask:0xf bank_mask:0xf
    v_fmac_f32_dpp v41, v37, v197 quad_perm:[1,1,1,1] row_mask:0xf bank_mask:0xf
    v_fmac_f32_dpp v42, v37, v198 quad_perm:[1,1,1,1] row_mask:0xf bank_mask:0xf
    v_fmac_f32_dpp v43, v37, v199 quad_perm:[1,1,1,1] row_mask:0xf bank_mask:0xf
    v_fmac_f32_dpp v40, v37, v200 quad_perm:[2,2,2,2] row_mask:0xf bank_mask:0xf
    v_fmac_f32_dpp v41, v37, v201 quad_perm:[2,2,2,2] row_mask:0xf bank_mask:0xf
    v_fmac_f32_dpp v42, v37, v202 quad_perm:[2,2,2,2] row_mask:0xf bank_mask:0xf
    v_fmac_f32_dpp v43, v37, v203 quad_perm:[2,2,2,2] row_mask:0xf bank_mask:0xf
    v_fmac_f32_dpp v40, v37, v204 quad_perm:[3,3,3,3] row_mask:0xf bank_mask:0xf
    v_fmac_f32_dpp v41, v37, v205 quad_perm:[3,3,3,3] row_mask:0xf bank_mask:0xf
    v_fmac_f32_dpp v42, v37, v206 quad_perm:[3,3,3,3] row_mask:0xf bank_mask:0xf
    v_fmac_f32_dpp v43, v37, v207 quad_perm:[3,3,3,3] row_mask:0xf bank_mask:0xf
    v_mul_f32 v40, v40, v38
    v_mul_f32 v41, v41, v38
    v_mul_f32 v42, v42, v38
    v_mul_f32 v43, v43, v38
    v_cvt_pk_bf16_f32 v32, v40, v41
    v_cvt_pk_bf16_f32 v33, v42, v43
    ds_write_b64 v29, v[32:33]
    s_lshl_b32 s58, s14, 12
    s_add_u32 s58, s58, 5242880
    s_lshl_b32 s59, s14, 10
    s_add_u32 s59, s59, 3670016
    s_lshl_b32 s60, s14, 7
    s_add_u32 s60, s60, 2883584
    s_lshl_b32 s61, s6, 7
    s_add_u32 s61, s61, 2949120
    v_mov_b32 v35, s8
    v_mov_b32 v39, s8
    v_mov_b32 v43, s8
    s_waitcnt lgkmcnt(0)
    s_barrier
    ds_read_b128 v[192:195], v8 offset:0
    ds_read_b128 v[196:199], v8 offset:64
    ds_read_b128 v[200:203], v8 offset:128
    ds_read_b128 v[204:207], v8 offset:192
    s_waitcnt lgkmcnt(0)
    v_mfma_f32_16x16x32_bf16 v[208:211], v[64:67], v[192:195], 0
    v_mfma_f32_16x16x32_bf16 v[212:215], v[80:83], v[192:195], 0
    v_mfma_f32_16x16x32_bf16 v[208:211], v[68:71], v[196:199], v[208:211]
    v_mfma_f32_16x16x32_bf16 v[212:215], v[84:87], v[196:199], v[212:215]
    v_mfma_f32_16x16x32_bf16 v[208:211], v[72:75], v[200:203], v[208:211]
    v_mfma_f32_16x16x32_bf16 v[212:215], v[88:91], v[200:203], v[212:215]
    v_mfma_f32_16x16x32_bf16 v[208:211], v[76:79], v[204:207], v[208:211]
    v_mfma_f32_16x16x32_bf16 v[212:215], v[92:95], v[204:207], v[212:215]
    v_mfma_f32_16x16x32_bf16 v[216:219], v[96:99], v[192:195], 0
    v_mfma_f32_16x16x32_bf16 v[220:223], v[112:115], v[192:195], 0
    v_mfma_f32_16x16x32_bf16 v[216:219], v[100:103], v[196:199], v[216:219]
    v_mfma_f32_16x16x32_bf16 v[220:223], v[116:119], v[196:199], v[220:223]
    v_mfma_f32_16x16x32_bf16 v[216:219], v[104:107], v[200:203], v[216:219]
    v_mfma_f32_16x16x32_bf16 v[220:223], v[120:123], v[200:203], v[220:223]
    v_mfma_f32_16x16x32_bf16 v[216:219], v[108:111], v[204:207], v[216:219]
    v_mfma_f32_16x16x32_bf16 v[220:223], v[124:127], v[204:207], v[220:223]
    v_cndmask_b32 v12, v208, v212, s[66:67]
    v_cndmask_b32 v13, v209, v213, s[66:67]
    v_cndmask_b32 v14, v210, v214, s[66:67]
    v_cndmask_b32 v15, v211, v215, s[66:67]
    v_perm_b32 v32, v12, v15, s52
    v_perm_b32 v33, v13, v15, s53
    v_perm_b32 v34, v14, v15, s54
    buffer_store_dwordx4 v[32:35], v28, s[36:39], s9 offen sc1
    v_mfma_f32_16x16x32_bf16 v[224:227], v[128:131], v[192:195], 0
    v_mfma_f32_16x16x32_bf16 v[228:231], v[144:147], v[192:195], 0
    v_mfma_f32_16x16x32_bf16 v[224:227], v[132:135], v[196:199], v[224:227]
    v_mfma_f32_16x16x32_bf16 v[228:231], v[148:151], v[196:199], v[228:231]
    v_mfma_f32_16x16x32_bf16 v[224:227], v[136:139], v[200:203], v[224:227]
    v_mfma_f32_16x16x32_bf16 v[228:231], v[152:155], v[200:203], v[228:231]
    v_mfma_f32_16x16x32_bf16 v[224:227], v[140:143], v[204:207], v[224:227]
    v_mfma_f32_16x16x32_bf16 v[228:231], v[156:159], v[204:207], v[228:231]
    v_cndmask_b32 v12, v216, v220, s[66:67]
    v_cndmask_b32 v13, v217, v221, s[66:67]
    v_cndmask_b32 v14, v218, v222, s[66:67]
    v_cndmask_b32 v15, v219, v223, s[66:67]
    v_perm_b32 v36, v12, v15, s52
    v_perm_b32 v37, v13, v15, s53
    v_perm_b32 v38, v14, v15, s54
    buffer_store_dwordx4 v[36:39], v28, s[36:39], s10 offen sc1
    v_mfma_f32_16x16x32_bf16 v[232:235], v[160:163], v[192:195], 0
    v_mfma_f32_16x16x32_bf16 v[236:239], v[176:179], v[192:195], 0
    v_mfma_f32_16x16x32_bf16 v[232:235], v[164:167], v[196:199], v[232:235]
    v_mfma_f32_16x16x32_bf16 v[236:239], v[180:183], v[196:199], v[236:239]
    v_mfma_f32_16x16x32_bf16 v[232:235], v[168:171], v[200:203], v[232:235]
    v_mfma_f32_16x16x32_bf16 v[236:239], v[184:187], v[200:203], v[236:239]
    v_mfma_f32_16x16x32_bf16 v[232:235], v[172:175], v[204:207], v[232:235]
    v_mfma_f32_16x16x32_bf16 v[236:239], v[188:191], v[204:207], v[236:239]
    v_cndmask_b32 v12, v224, v228, s[66:67]
    v_cndmask_b32 v13, v225, v229, s[66:67]
    v_cndmask_b32 v14, v226, v230, s[66:67]
    v_cndmask_b32 v15, v227, v231, s[66:67]
    v_perm_b32 v40, v12, v15, s52
    v_perm_b32 v41, v13, v15, s53
    v_perm_b32 v42, v14, v15, s54
    buffer_store_dwordx4 v[40:43], v28, s[36:39], s12 offen sc1
    s_nop 0
    v_cndmask_b32 v12, v232, v236, s[66:67]
    v_cndmask_b32 v13, v233, v237, s[66:67]
    v_cndmask_b32 v14, v234, v238, s[66:67]
    v_cndmask_b32 v15, v235, v239, s[66:67]
    v_perm_b32 v44, v12, v15, s52
    v_perm_b32 v45, v13, v15, s53
    v_perm_b32 v46, v14, v15, s54
    buffer_store_dwordx4 v[44:47], v28, s[36:39], s13 offen sc1
    s_sleep 12
    buffer_load_dwordx4 v[192:195], v63, s[36:39], s58 offen offset:0 sc1
    buffer_load_dwordx4 v[196:199], v63, s[36:39], s58 offen offset:1024 sc1
    buffer_load_dwordx4 v[200:203], v63, s[36:39], s58 offen offset:2048 sc1
    buffer_load_dwordx4 v[204:207], v63, s[36:39], s58 offen offset:3072 sc1
    s_mov_b32 s57, 0
    s_waitcnt vmcnt(0)
    v_xor_b32 v10, s8, v195
    v_bitop3_b32 v10, v10, v199, s8 bitop3:0xF6
    v_bitop3_b32 v10, v10, v203, s8 bitop3:0xF6
    v_bitop3_b32 v10, v10, v207, s8 bitop3:0xF6
    v_cmp_ne_u32 vcc, 0, v10
    s_cbranch_vccz L_ge_9
L_g_8:
    s_sleep 4
    buffer_load_dwordx4 v[192:195], v63, s[36:39], s58 offen offset:0 sc1
    buffer_load_dwordx4 v[196:199], v63, s[36:39], s58 offen offset:1024 sc1
    buffer_load_dwordx4 v[200:203], v63, s[36:39], s58 offen offset:2048 sc1
    buffer_load_dwordx4 v[204:207], v63, s[36:39], s58 offen offset:3072 sc1
    s_add_u32 s57, s57, 1
    s_waitcnt vmcnt(0)
    v_xor_b32 v10, s8, v195
    v_bitop3_b32 v10, v10, v199, s8 bitop3:0xF6
    v_bitop3_b32 v10, v10, v203, s8 bitop3:0xF6
    v_bitop3_b32 v10, v10, v207, s8 bitop3:0xF6
    v_cmp_ne_u32 vcc, 0, v10
    s_cbranch_vccz L_ge_9
    s_cmp_lt_u32 s57, 150000
    s_cbranch_scc1 L_g_8
L_ge_9:
    v_perm_b32 v195, v193, v192, s55
    v_perm_b32 v195, v194, v195, s56
    v_perm_b32 v199, v197, v196, s55
    v_perm_b32 v199, v198, v199, s56
    v_perm_b32 v203, v201, v200, s55
    v_perm_b32 v203, v202, v203, s56
    v_perm_b32 v207, v205, v204, s55
    v_perm_b32 v207, v206, v207, s56
    v_pk_add_f32 v[192:193], v[192:193], v[196:197]
    v_pk_add_f32 v[200:201], v[200:201], v[204:205]
    v_pk_add_f32 v[194:195], v[194:195], v[198:199]
    v_pk_add_f32 v[202:203], v[202:203], v[206:207]
    v_pk_add_f32 v[192:193], v[192:193], v[200:201]
    v_pk_add_f32 v[194:195], v[194:195], v[202:203]
    s_nop 0
    v_add_f32_dpp v192, v192, v192 row_ror:8 row_mask:0xf bank_mask:0xf
    v_add_f32_dpp v193, v193, v193 row_ror:8 row_mask:0xf bank_mask:0xf
    v_add_f32_dpp v194, v194, v194 row_ror:8 row_mask:0xf bank_mask:0xf
    v_add_f32_dpp v195, v195, v195 row_ror:8 row_mask:0xf bank_mask:0xf
    v_mov_b32 v12, v192
    v_mov_b32 v13, v193
    v_mov_b32 v14, v194
    v_mov_b32 v15, v195
    v_permlane16_swap_b32 v192, v12
    v_permlane16_swap_b32 v193, v13
    v_permlane16_swap_b32 v194, v14
    v_permlane16_swap_b32 v195, v15
    v_add_f32 v192, v192, v12
    v_add_f32 v193, v193, v13
    v_add_f32 v194, v194, v14
    v_add_f32 v195, v195, v15
    v_mov_b32 v12, v192
    v_mov_b32 v13, v193
    v_mov_b32 v14, v194
    v_mov_b32 v15, v195
    v_permlane32_swap_b32 v192, v12
    v_permlane32_swap_b32 v193, v13
    v_permlane32_swap_b32 v194, v14
    v_permlane32_swap_b32 v195, v15
    v_add_f32 v192, v192, v12
    v_add_f32 v193, v193, v13
    v_add_f32 v194, v194, v14
    v_add_f32 v195, v195, v15
    v_cvt_pk_bf16_f32 v12, v192, v193
    v_cvt_pk_bf16_f32 v13, v194, v195
    v_lshlrev_b32 v40, 16, v12
    v_and_b32 v41, 0xffff0000, v12
    v_lshlrev_b32 v42, 16, v13
    v_and_b32 v43, 0xffff0000, v13
    v_pk_add_f32 v[40:41], v[40:41], v[56:57]
    v_pk_add_f32 v[42:43], v[42:43], v[58:59]
    v_pk_mul_f32 v[44:45], v[40:41], v[40:41]
    v_cvt_pk_bf16_f32 v48, v40, v41
    v_pk_fma_f32 v[44:45], v[42:43], v[42:43], v[44:45]
    v_cvt_pk_bf16_f32 v49, v42, v43
    v_add_f32 v50, v44, v45
    s_mov_b32 exec_lo, 0xff
    s_mov_b32 exec_hi, 0x0
    buffer_store_dwordx4 v[48:51], v63, s[36:39], s60 offen sc1
    s_cmp_lg_u32 s3, 0
    s_cbranch_scc1 L_hp_10
    s_lshl_b32 s15, s4, 4
    s_add_u32 s15, s15, s7
    s_lshl_b32 s15, s15, 4
    s_add_u32 s15, s15, 3016704
    v_mov_b32 v12, 0
    s_mov_b64 exec, 1
    buffer_store_dword v55, v12, s[36:39], s15 offen
    s_mov_b64 exec, -1
L_hp_10:
    s_mov_b64 exec, -1
    v_lshlrev_b32 v56, 16, v48
    v_and_b32 v57, 0xffff0000, v48
    v_lshlrev_b32 v58, 16, v49
    v_and_b32 v59, 0xffff0000, v49
    v_and_b32 v12, 15, v1
    v_lshlrev_b32 v12, 4, v12
    s_lshl_b32 s15, s4, 8
    s_add_u32 s15, s15, 3018752
    s_mov_b32 s57, 0
L_hu_11:
    buffer_load_dword v13, v12, s[36:39], s15 offen sc1
    s_add_u32 s57, s57, 1
    s_waitcnt vmcnt(0)
    v_cmp_ne_u32 vcc, s8, v13
    s_cbranch_vccz L_hue_12
    s_cmp_lt_u32 s57, 400
    s_cbranch_scc1 L_hu_11
L_hue_12:
    buffer_load_dwordx4 v[192:195], v63, s[36:39], s59 offen offset:0 sc1
    s_mov_b32 s57, 0
    s_waitcnt vmcnt(0)
    v_xor_b32 v10, s8, v195
    v_cmp_ne_u32 vcc, 0, v10
    s_cbranch_vccz L_ge_14
L_g_13:
    s_sleep 4
    buffer_load_dwordx4 v[192:195], v63, s[36:39], s59 offen offset:0 sc1
    s_add_u32 s57, s57, 1
    s_waitcnt vmcnt(0)
    v_xor_b32 v10, s8, v195
    v_cmp_ne_u32 vcc, 0, v10
    s_cbranch_vccz L_ge_14
    s_cmp_lt_u32 s57, 150000
    s_cbranch_scc1 L_g_13
L_ge_14:
    v_perm_b32 v195, v193, v192, s55
    v_perm_b32 v195, v194, v195, s56
    v_add_f32_dpp v192, v192, v192 row_ror:8 row_mask:0xf bank_mask:0xf
    v_add_f32_dpp v193, v193, v193 row_ror:8 row_mask:0xf bank_mask:0xf
    v_add_f32_dpp v194, v194, v194 row_ror:8 row_mask:0xf bank_mask:0xf
    v_add_f32_dpp v195, v195, v195 row_ror:8 row_mask:0xf bank_mask:0xf
    v_mov_b32 v12, v192
    v_mov_b32 v13, v193
    v_mov_b32 v14, v194
    v_mov_b32 v15, v195
    v_permlane16_swap_b32 v192, v12
    v_permlane16_swap_b32 v193, v13
    v_permlane16_swap_b32 v194, v14
    v_permlane16_swap_b32 v195, v15
    v_add_f32 v192, v192, v12
    v_add_f32 v193, v193, v13
    v_add_f32 v194, v194, v14
    v_add_f32 v195, v195, v15
    v_mov_b32 v12, v192
    v_mov_b32 v13, v193
    v_mov_b32 v14, v194
    v_mov_b32 v15, v195
    v_permlane32_swap_b32 v192, v12
    v_permlane32_swap_b32 v193, v13
    v_permlane32_swap_b32 v194, v14
    v_permlane32_swap_b32 v195, v15
    v_add_f32 v192, v192, v12
    v_add_f32 v193, v193, v13
    v_add_f32 v194, v194, v14
    v_add_f32 v195, v195, v15
    v_cvt_pk_bf16_f32 v12, v192, v193
    v_cvt_pk_bf16_f32 v13, v194, v195
    v_lshlrev_b32 v40, 16, v12
    v_and_b32 v41, 0xffff0000, v12
    v_lshlrev_b32 v42, 16, v13
    v_and_b32 v43, 0xffff0000, v13
    v_pk_add_f32 v[40:41], v[40:41], v[56:57]
    v_pk_add_f32 v[42:43], v[42:43], v[58:59]
    v_cvt_pk_bf16_f32 v48, v40, v41
    v_cvt_pk_bf16_f32 v49, v42, v43
    s_mov_b32 exec_lo, 0xff
    s_mov_b32 exec_hi, 0x0
    buffer_store_dwordx2 v[48:49], v62, s[40:43], s68 offen
    s_mov_b64 exec, 1
    s_cmp_lg_u32 s14, 0
    s_cbranch_scc1 L_done
    v_mov_b32 v12, s8
    v_mov_b32 v13, 0
    buffer_store_dword v12, v13, s[36:39], 0 offen sc1
    s_branch L_done
L_f1:
    s_movk_i32 s12, 7168
    v_mul_lo_u32 v22, v20, s12
    v_add_u32 v4, v22, v21
    v_xor_b32 v5, 64, v4
    s_mov_b32 s44, s28
    s_mov_b32 s45, s29
    s_mov_b32 s46, 7340032
    s_mov_b32 s47, 0x20000
    s_mul_i32 s12, s4, 7
    s_add_u32 s12, s12, s7
    s_sub_u32 s12, s12, 8
    s_lshl_b32 s13, s12, 7
    s_mul_i32 s14, s3, 1835008
    s_add_u32 s63, s13, s14
    s_mov_b32 m0, s64
    s_waitcnt vmcnt(0)
    buffer_load_dwordx4 v4, s[44:47], s63 offen offset:0 nt lds
    s_waitcnt vmcnt(0)
    s_add_u32 s15, s63, 56320
    buffer_load_dwordx4 v5, s[44:47], s15 offen offset:1024 nt lds
    s_waitcnt vmcnt(0)
    s_add_u32 s15, s63, 112640
    buffer_load_dwordx4 v4, s[44:47], s15 offen offset:2048 nt lds
    s_waitcnt vmcnt(0)
    s_add_u32 s15, s63, 168960
    buffer_load_dwordx4 v5, s[44:47], s15 offen offset:3072 nt lds
    s_add_u32 s63, s63, 229376
    s_add_u32 s64, s64, 4096
    s_mov_b32 m0, s64
    s_waitcnt vmcnt(0)
    buffer_load_dwordx4 v4, s[44:47], s63 offen offset:0 nt lds
    s_waitcnt vmcnt(9)
    s_add_u32 s15, s63, 56320
    buffer_load_dwordx4 v5, s[44:47], s15 offen offset:1024 nt lds
    s_waitcnt vmcnt(9)
    s_add_u32 s15, s63, 112640
    buffer_load_dwordx4 v4, s[44:47], s15 offen offset:2048 nt lds
    s_waitcnt vmcnt(9)
    s_add_u32 s15, s63, 168960
    buffer_load_dwordx4 v5, s[44:47], s15 offen offset:3072 nt lds
    s_add_u32 s63, s63, 229376
    s_add_u32 s64, s64, 4096
    s_mov_b32 s65, 0
L_dl_15:
    s_mov_b32 m0, s64
    s_waitcnt vmcnt(9)
    buffer_load_dwordx4 v4, s[44:47], s63 offen offset:0 nt lds
    s_waitcnt vmcnt(9)
    s_add_u32 s15, s63, 56320
    buffer_load_dwordx4 v5, s[44:47], s15 offen offset:1024 nt lds
    s_waitcnt vmcnt(9)
    s_add_u32 s15, s63, 112640
    buffer_load_dwordx4 v4, s[44:47], s15 offen offset:2048 nt lds
    s_waitcnt vmcnt(9)
    s_add_u32 s15, s63, 168960
    buffer_load_dwordx4 v5, s[44:47], s15 offen offset:3072 nt lds
    s_add_u32 s63, s63, 229376
    s_add_u32 s64, s64, 4096
    s_add_u32 s65, s65, 1
    s_cmp_lt_u32 s65, 6
    s_cbranch_scc1 L_dl_15
    v_mul_u32_u24 v22, 2080, v19
    v_lshrrev_b32 v27, 3, v0
    v_lshl_add_u32 v29, v27, 3, v22
    v_add_u32 v29, 131072, v29
    v_lshl_add_u32 v8, v3, 4, v22
    v_add_u32 v8, 131072, v8
    v_and_b32 v22, 8, v1
    v_lshl_add_u32 v8, v22, 3, v8
    s_lshl_b32 s13, s3, 9
    v_lshlrev_b32 v22, 7, v3
    v_lshl_add_u32 v28, v2, 4, v22
    v_add_u32 v28, s13, v28
    s_lshl_b32 s9, s12, 11
    s_add_u32 s9, s9, 3407872
    s_add_u32 s10, s9, 4194304
    s_mov_b32 s58, 2883584
    s_mov_b32 s59, 2891776
    s_mov_b32 s60, 2899968
    s_mov_b32 s61, 2908160
    v_add_u32 v30, 4096, v9
    v_mov_b32 v12, 0x3f803f80
    v_mov_b32 v13, v12
    v_mov_b32 v14, v12
    v_mov_b32 v15, v12
    s_mov_b32 s68, 2949120
    s_lshl_b32 s13, s3, 6
    v_lshl_add_u32 v31, v19, 3, s13
    v_add_u32 v31, 147712, v31
    v_lshlrev_b32 v27, 3, v19
    v_add_u32 v27, 147712, v27
    v_mov_b32 v46, s8
    v_mov_b32 v47, s8
    v_and_b32 v40, 7, v1
    v_lshlrev_b32 v40, 4, v40
    s_lshl_b32 s15, s4, 8
    s_add_u32 s15, s15, 3016704
    buffer_load_dword v41, v40, s[36:39], s15 offen sc1
    s_waitcnt vmcnt(0)
    s_barrier
    v_cmp_ne_u32 vcc, s8, v41
    s_cbranch_vccnz L_st_16
    buffer_load_dwordx4 v[192:195], v9, s[36:39], s58 offen sc1
    buffer_load_dwordx4 v[196:199], v30, s[36:39], s58 offen sc1
    buffer_load_dwordx4 v[200:203], v9, s[36:39], s59 offen sc1
    buffer_load_dwordx4 v[204:207], v30, s[36:39], s59 offen sc1
    buffer_load_dwordx4 v[208:211], v9, s[36:39], s60 offen sc1
    buffer_load_dwordx4 v[212:215], v30, s[36:39], s60 offen sc1
    buffer_load_dwordx4 v[216:219], v9, s[36:39], s61 offen sc1
    buffer_load_dwordx4 v[220:223], v30, s[36:39], s61 offen sc1
L_st_16:
    s_mov_b64 s[0:1], vcc
    ds_read_b64_tr_b16 v[64:65], v6 offset:0
    ds_read_b64_tr_b16 v[66:67], v6 offset:512
    ds_read_b64_tr_b16 v[68:69], v6 offset:4096
    ds_read_b64_tr_b16 v[70:71], v6 offset:4608
    ds_read_b64_tr_b16 v[72:73], v6 offset:8192
    ds_read_b64_tr_b16 v[74:75], v6 offset:8704
    ds_read_b64_tr_b16 v[76:77], v6 offset:12288
    ds_read_b64_tr_b16 v[78:79], v6 offset:12800
    ds_read_b64_tr_b16 v[80:81], v6 offset:16384
    ds_read_b64_tr_b16 v[82:83], v6 offset:16896
    ds_read_b64_tr_b16 v[84:85], v6 offset:20480
    ds_read_b64_tr_b16 v[86:87], v6 offset:20992
    ds_read_b64_tr_b16 v[88:89], v6 offset:24576
    ds_read_b64_tr_b16 v[90:91], v6 offset:25088
    s_waitcnt lgkmcnt(12)
    v_mfma_f32_16x16x32_bf16 v[36:39], v[64:67], v[12:15], 0
    ds_read_b64_tr_b16 v[92:93], v6 offset:28672
    ds_read_b64_tr_b16 v[94:95], v6 offset:29184
    s_waitcnt lgkmcnt(12)
    v_mfma_f32_16x16x32_bf16 v[36:39], v[68:71], v[12:15], v[36:39]
    ds_read_b64_tr_b16 v[96:97], v6 offset:32768
    ds_read_b64_tr_b16 v[98:99], v6 offset:33280
    s_waitcnt lgkmcnt(12)
    v_mfma_f32_16x16x32_bf16 v[36:39], v[72:75], v[12:15], v[36:39]
    ds_read_b64_tr_b16 v[100:101], v6 offset:36864
    ds_read_b64_tr_b16 v[102:103], v6 offset:37376
    s_waitcnt lgkmcnt(12)
    v_mfma_f32_16x16x32_bf16 v[36:39], v[76:79], v[12:15], v[36:39]
    ds_read_b64_tr_b16 v[104:105], v6 offset:40960
    ds_read_b64_tr_b16 v[106:107], v6 offset:41472
    s_waitcnt lgkmcnt(12)
    v_mfma_f32_16x16x32_bf16 v[36:39], v[80:83], v[12:15], v[36:39]
    ds_read_b64_tr_b16 v[108:109], v6 offset:45056
    ds_read_b64_tr_b16 v[110:111], v6 offset:45568
    s_waitcnt lgkmcnt(12)
    v_mfma_f32_16x16x32_bf16 v[36:39], v[84:87], v[12:15], v[36:39]
    ds_read_b64_tr_b16 v[112:113], v6 offset:49152
    ds_read_b64_tr_b16 v[114:115], v6 offset:49664
    s_waitcnt lgkmcnt(12)
    v_mfma_f32_16x16x32_bf16 v[36:39], v[88:91], v[12:15], v[36:39]
    ds_read_b64_tr_b16 v[116:117], v6 offset:53248
    ds_read_b64_tr_b16 v[118:119], v6 offset:53760
    s_waitcnt lgkmcnt(12)
    v_mfma_f32_16x16x32_bf16 v[36:39], v[92:95], v[12:15], v[36:39]
    ds_read_b64_tr_b16 v[120:121], v6 offset:57344
    ds_read_b64_tr_b16 v[122:123], v6 offset:57856
    s_waitcnt lgkmcnt(12)
    v_mfma_f32_16x16x32_bf16 v[36:39], v[96:99], v[12:15], v[36:39]
    ds_read_b64_tr_b16 v[124:125], v6 offset:61440
    ds_read_b64_tr_b16 v[126:127], v6 offset:61952
    s_waitcnt lgkmcnt(12)
    v_mfma_f32_16x16x32_bf16 v[36:39], v[100:103], v[12:15], v[36:39]
    ds_read_b64_tr_b16 v[128:129], v7 offset:0
    ds_read_b64_tr_b16 v[130:131], v7 offset:512
    s_waitcnt lgkmcnt(12)
    v_mfma_f32_16x16x32_bf16 v[36:39], v[104:107], v[12:15], v[36:39]
    ds_read_b64_tr_b16 v[132:133], v7 offset:4096
    ds_read_b64_tr_b16 v[134:135], v7 offset:4608
    s_waitcnt lgkmcnt(12)
    v_mfma_f32_16x16x32_bf16 v[36:39], v[108:111], v[12:15], v[36:39]
    ds_read_b64_tr_b16 v[136:137], v7 offset:8192
    ds_read_b64_tr_b16 v[138:139], v7 offset:8704
    s_waitcnt lgkmcnt(12)
    v_mfma_f32_16x16x32_bf16 v[36:39], v[112:115], v[12:15], v[36:39]
    ds_read_b64_tr_b16 v[140:141], v7 offset:12288
    ds_read_b64_tr_b16 v[142:143], v7 offset:12800
    s_waitcnt lgkmcnt(12)
    v_mfma_f32_16x16x32_bf16 v[36:39], v[116:119], v[12:15], v[36:39]
    ds_read_b64_tr_b16 v[144:145], v7 offset:16384
    ds_read_b64_tr_b16 v[146:147], v7 offset:16896
    s_waitcnt lgkmcnt(12)
    v_mfma_f32_16x16x32_bf16 v[36:39], v[120:123], v[12:15], v[36:39]
    ds_read_b64_tr_b16 v[148:149], v7 offset:20480
    ds_read_b64_tr_b16 v[150:151], v7 offset:20992
    s_waitcnt lgkmcnt(12)
    v_mfma_f32_16x16x32_bf16 v[36:39], v[124:127], v[12:15], v[36:39]
    ds_read_b64_tr_b16 v[152:153], v7 offset:24576
    ds_read_b64_tr_b16 v[154:155], v7 offset:25088
    s_waitcnt lgkmcnt(12)
    v_mfma_f32_16x16x32_bf16 v[36:39], v[128:131], v[12:15], v[36:39]
    ds_read_b64_tr_b16 v[156:157], v7 offset:28672
    ds_read_b64_tr_b16 v[158:159], v7 offset:29184
    s_waitcnt lgkmcnt(12)
    v_mfma_f32_16x16x32_bf16 v[36:39], v[132:135], v[12:15], v[36:39]
    ds_read_b64_tr_b16 v[160:161], v7 offset:32768
    ds_read_b64_tr_b16 v[162:163], v7 offset:33280
    s_waitcnt lgkmcnt(12)
    v_mfma_f32_16x16x32_bf16 v[36:39], v[136:139], v[12:15], v[36:39]
    ds_read_b64_tr_b16 v[164:165], v7 offset:36864
    ds_read_b64_tr_b16 v[166:167], v7 offset:37376
    s_waitcnt lgkmcnt(12)
    v_mfma_f32_16x16x32_bf16 v[36:39], v[140:143], v[12:15], v[36:39]
    ds_read_b64_tr_b16 v[168:169], v7 offset:40960
    ds_read_b64_tr_b16 v[170:171], v7 offset:41472
    s_waitcnt lgkmcnt(12)
    v_mfma_f32_16x16x32_bf16 v[36:39], v[144:147], v[12:15], v[36:39]
    ds_read_b64_tr_b16 v[172:173], v7 offset:45056
    ds_read_b64_tr_b16 v[174:175], v7 offset:45568
    s_waitcnt lgkmcnt(12)
    v_mfma_f32_16x16x32_bf16 v[36:39], v[148:151], v[12:15], v[36:39]
    ds_read_b64_tr_b16 v[176:177], v7 offset:49152
    ds_read_b64_tr_b16 v[178:179], v7 offset:49664
    s_waitcnt lgkmcnt(12)
    v_mfma_f32_16x16x32_bf16 v[36:39], v[152:155], v[12:15], v[36:39]
    ds_read_b64_tr_b16 v[180:181], v7 offset:53248
    ds_read_b64_tr_b16 v[182:183], v7 offset:53760
    s_waitcnt lgkmcnt(12)
    v_mfma_f32_16x16x32_bf16 v[36:39], v[156:159], v[12:15], v[36:39]
    ds_read_b64_tr_b16 v[184:185], v7 offset:57344
    ds_read_b64_tr_b16 v[186:187], v7 offset:57856
    s_waitcnt lgkmcnt(12)
    v_mfma_f32_16x16x32_bf16 v[36:39], v[160:163], v[12:15], v[36:39]
    ds_read_b64_tr_b16 v[188:189], v7 offset:61440
    ds_read_b64_tr_b16 v[190:191], v7 offset:61952
    s_waitcnt lgkmcnt(12)
    v_mfma_f32_16x16x32_bf16 v[36:39], v[164:167], v[12:15], v[36:39]
    s_waitcnt lgkmcnt(10)
    v_mfma_f32_16x16x32_bf16 v[36:39], v[168:171], v[12:15], v[36:39]
    s_waitcnt lgkmcnt(8)
    v_mfma_f32_16x16x32_bf16 v[36:39], v[172:175], v[12:15], v[36:39]
    s_waitcnt lgkmcnt(6)
    v_mfma_f32_16x16x32_bf16 v[36:39], v[176:179], v[12:15], v[36:39]
    s_waitcnt lgkmcnt(4)
    v_mfma_f32_16x16x32_bf16 v[36:39], v[180:183], v[12:15], v[36:39]
    s_waitcnt lgkmcnt(2)
    v_mfma_f32_16x16x32_bf16 v[36:39], v[184:187], v[12:15], v[36:39]
    s_waitcnt lgkmcnt(0)
    v_mfma_f32_16x16x32_bf16 v[36:39], v[188:191], v[12:15], v[36:39]
    s_cmp_eq_u64 s[0:1], 0
    s_cbranch_scc1 L_sg_17
    v_and_b32 v40, 7, v1
    v_lshlrev_b32 v40, 4, v40
    s_lshl_b32 s15, s4, 8
    s_add_u32 s15, s15, 3016704
    s_mov_b32 s57, 0
L_hu_18:
    buffer_load_dword v41, v40, s[36:39], s15 offen sc1
    s_add_u32 s57, s57, 1
    s_waitcnt vmcnt(0)
    v_cmp_ne_u32 vcc, s8, v41
    s_cbranch_vccz L_hue_19
    s_cmp_lt_u32 s57, 400
    s_cbranch_scc1 L_hu_18
L_hue_19:
    buffer_load_dwordx4 v[192:195], v9, s[36:39], s58 offen sc1
    buffer_load_dwordx4 v[196:199], v30, s[36:39], s58 offen sc1
    buffer_load_dwordx4 v[200:203], v9, s[36:39], s59 offen sc1
    buffer_load_dwordx4 v[204:207], v30, s[36:39], s59 offen sc1
    buffer_load_dwordx4 v[208:211], v9, s[36:39], s60 offen sc1
    buffer_load_dwordx4 v[212:215], v30, s[36:39], s60 offen sc1
    buffer_load_dwordx4 v[216:219], v9, s[36:39], s61 offen sc1
    buffer_load_dwordx4 v[220:223], v30, s[36:39], s61 offen sc1
L_sg_17:
    s_mov_b32 s57, 0
    s_waitcnt vmcnt(0)
    v_xor_b32 v10, s8, v195
    v_bitop3_b32 v10, v10, v199, s8 bitop3:0xF6
    v_bitop3_b32 v10, v10, v203, s8 bitop3:0xF6
    v_bitop3_b32 v10, v10, v207, s8 bitop3:0xF6
    v_bitop3_b32 v10, v10, v211, s8 bitop3:0xF6
    v_bitop3_b32 v10, v10, v215, s8 bitop3:0xF6
    v_bitop3_b32 v10, v10, v219, s8 bitop3:0xF6
    v_bitop3_b32 v10, v10, v223, s8 bitop3:0xF6
    v_cmp_ne_u32 vcc, 0, v10
    s_cbranch_vccz L_ge_21
L_g_20:
    s_sleep 4
    buffer_load_dwordx4 v[192:195], v9, s[36:39], s58 offen sc1
    buffer_load_dwordx4 v[196:199], v30, s[36:39], s58 offen sc1
    buffer_load_dwordx4 v[200:203], v9, s[36:39], s59 offen sc1
    buffer_load_dwordx4 v[204:207], v30, s[36:39], s59 offen sc1
    buffer_load_dwordx4 v[208:211], v9, s[36:39], s60 offen sc1
    buffer_load_dwordx4 v[212:215], v30, s[36:39], s60 offen sc1
    buffer_load_dwordx4 v[216:219], v9, s[36:39], s61 offen sc1
    buffer_load_dwordx4 v[220:223], v30, s[36:39], s61 offen sc1
    s_add_u32 s57, s57, 1
    s_waitcnt vmcnt(0)
    v_xor_b32 v10, s8, v195
    v_bitop3_b32 v10, v10, v199, s8 bitop3:0xF6
    v_bitop3_b32 v10, v10, v203, s8 bitop3:0xF6
    v_bitop3_b32 v10, v10, v207, s8 bitop3:0xF6
    v_bitop3_b32 v10, v10, v211, s8 bitop3:0xF6
    v_bitop3_b32 v10, v10, v215, s8 bitop3:0xF6
    v_bitop3_b32 v10, v10, v219, s8 bitop3:0xF6
    v_bitop3_b32 v10, v10, v223, s8 bitop3:0xF6
    v_cmp_ne_u32 vcc, 0, v10
    s_cbranch_vccz L_ge_21
    s_cmp_lt_u32 s57, 150000
    s_cbranch_scc1 L_g_20
L_ge_21:
    ds_write_b64 v29, v[192:193] offset:0
    ds_write_b64 v29, v[196:197] offset:256
    ds_write_b64 v29, v[200:201] offset:512
    ds_write_b64 v29, v[204:205] offset:768
    ds_write_b64 v29, v[208:209] offset:1024
    ds_write_b64 v29, v[212:213] offset:1280
    ds_write_b64 v29, v[216:217] offset:1536
    ds_write_b64 v29, v[220:221] offset:1792
    v_dot2_f32_bf16 v40, v192, v12, 0
    v_dot2_f32_bf16 v42, v193, v12, 0
    v_dot2_f32_bf16 v40, v196, v12, v40
    v_dot2_f32_bf16 v42, v197, v12, v42
    v_dot2_f32_bf16 v40, v200, v12, v40
    v_dot2_f32_bf16 v42, v201, v12, v42
    v_dot2_f32_bf16 v40, v204, v12, v40
    v_dot2_f32_bf16 v42, v205, v12, v42
    v_dot2_f32_bf16 v40, v208, v12, v40
    v_dot2_f32_bf16 v42, v209, v12, v42
    s_waitcnt lgkmcnt(0)
    s_barrier
    ds_read_b128 v[224:227], v8 offset:0
    ds_read_b128 v[228:231], v8 offset:128
    ds_read_b128 v[232:235], v8 offset:256
    ds_read_b128 v[236:239], v8 offset:384
    ds_read_b128 v[240:243], v8 offset:512
    ds_read_b128 v[244:247], v8 offset:640
    ds_read_b128 v[248:251], v8 offset:768
    ds_read_b128 v[252:255], v8 offset:896
    v_dot2_f32_bf16 v40, v212, v12, v40
    v_dot2_f32_bf16 v42, v213, v12, v42
    v_dot2_f32_bf16 v40, v216, v12, v40
    v_dot2_f32_bf16 v42, v217, v12, v42
    v_dot2_f32_bf16 v40, v220, v12, v40
    v_dot2_f32_bf16 v42, v221, v12, v42
    v_add_f32 v41, v198, v194
    v_add_f32 v41, v202, v41
    v_add_f32 v41, v206, v41
    v_add_f32 v41, v210, v41
    v_add_f32 v41, v214, v41
    v_add_f32 v41, v218, v41
    v_add_f32 v41, v222, v41
    s_waitcnt lgkmcnt(7)
    v_mfma_f32_16x16x32_bf16 v[32:35], v[64:67], v[224:227], 0
    v_add_f32 v40, v40, v42
    v_mfma_f32_16x16x32_bf16 v[56:59], v[68:71], v[224:227], 0
    ds_read_b128 v[224:227], v8 offset:1024
    v_add_f32_dpp v40, v40, v40 row_ror:8 row_mask:0xf bank_mask:0xf
    v_add_f32_dpp v41, v41, v41 row_ror:8 row_mask:0xf bank_mask:0xf
    s_waitcnt lgkmcnt(7)
    v_mfma_f32_16x16x32_bf16 v[32:35], v[72:75], v[228:231], v[32:35]
    v_mov_b32 v42, v40
    v_mov_b32 v43, v41
    v_mfma_f32_16x16x32_bf16 v[56:59], v[76:79], v[228:231], v[56:59]
    ds_read_b128 v[228:231], v8 offset:1152
    v_permlane16_swap_b32 v40, v42
    v_permlane16_swap_b32 v41, v43
    s_waitcnt lgkmcnt(7)
    v_mfma_f32_16x16x32_bf16 v[32:35], v[80:83], v[232:235], v[32:35]
    v_pk_add_f32 v[40:41], v[40:41], v[42:43]
    v_mfma_f32_16x16x32_bf16 v[56:59], v[84:87], v[232:235], v[56:59]
    ds_read_b128 v[232:235], v8 offset:1280
    v_mov_b32 v42, v40
    v_mov_b32 v43, v41
    s_waitcnt lgkmcnt(7)
    v_mfma_f32_16x16x32_bf16 v[32:35], v[88:91], v[236:239], v[32:35]
    v_permlane32_swap_b32 v40, v42
    v_permlane32_swap_b32 v41, v43
    v_mfma_f32_16x16x32_bf16 v[56:59], v[92:95], v[236:239], v[56:59]
    ds_read_b128 v[236:239], v8 offset:1408
    v_pk_add_f32 v[40:41], v[40:41], v[42:43]
    s_waitcnt lgkmcnt(7)
    v_mfma_f32_16x16x32_bf16 v[32:35], v[96:99], v[240:243], v[32:35]
    s_mov_b32 exec_lo, 0xff
    s_mov_b32 exec_hi, 0
    ds_write_b64 v31, v[40:41]
    s_mov_b64 exec, -1
    v_mfma_f32_16x16x32_bf16 v[56:59], v[100:103], v[240:243], v[56:59]
    ds_read_b128 v[240:243], v8 offset:1536
    s_waitcnt lgkmcnt(8)
    v_mfma_f32_16x16x32_bf16 v[32:35], v[104:107], v[244:247], v[32:35]
    s_waitcnt lgkmcnt(1)
    v_mfma_f32_16x16x32_bf16 v[56:59], v[108:111], v[244:247], v[56:59]
    ds_read_b128 v[244:247], v8 offset:1664
    s_barrier
    ds_read_b64 v[48:49], v27 offset:0
    ds_read_b64 v[50:51], v27 offset:64
    ds_read_b64 v[52:53], v27 offset:128
    ds_read_b64 v[54:55], v27 offset:192
    s_waitcnt lgkmcnt(12)
    v_mfma_f32_16x16x32_bf16 v[32:35], v[112:115], v[248:251], v[32:35]
    v_mfma_f32_16x16x32_bf16 v[56:59], v[116:119], v[248:251], v[56:59]
    ds_read_b128 v[248:251], v8 offset:1792
    s_waitcnt lgkmcnt(12)
    v_mfma_f32_16x16x32_bf16 v[32:35], v[120:123], v[252:255], v[32:35]
    v_mfma_f32_16x16x32_bf16 v[56:59], v[124:127], v[252:255], v[56:59]
    ds_read_b128 v[252:255], v8 offset:1920
    s_waitcnt lgkmcnt(2)
    v_mfma_f32_16x16x32_bf16 v[32:35], v[128:131], v[224:227], v[32:35]
    v_pk_add_f32 v[48:49], v[48:49], v[50:51]
    v_pk_add_f32 v[52:53], v[52:53], v[54:55]
    v_pk_add_f32 v[48:49], v[48:49], v[52:53]
    v_mfma_f32_16x16x32_bf16 v[56:59], v[132:135], v[224:227], v[56:59]
    v_mul_f32 v48, 0x3a800000, v48
    v_mul_f32 v49, 0x3a800000, v49
    v_fma_f32 v49, -v48, v48, v49
    s_waitcnt lgkmcnt(11)
    v_mfma_f32_16x16x32_bf16 v[32:35], v[136:139], v[228:231], v[32:35]
    v_max_f32 v49, 0, v49
    v_cvt_pk_bf16_f32 v49, v49, v49
    v_lshlrev_b32 v49, 16, v49
    v_mfma_f32_16x16x32_bf16 v[56:59], v[140:143], v[228:231], v[56:59]
    v_add_f32 v49, 0x3727c5ac, v49
    v_cvt_pk_bf16_f32 v49, v49, v49
    v_lshlrev_b32 v49, 16, v49
    s_waitcnt lgkmcnt(10)
    v_mfma_f32_16x16x32_bf16 v[32:35], v[144:147], v[232:235], v[32:35]
    v_sqrt_f32 v49, v49
    v_cvt_pk_bf16_f32 v48, v48, v48
    v_mfma_f32_16x16x32_bf16 v[56:59], v[148:151], v[232:235], v[56:59]
    v_cvt_pk_bf16_f32 v49, v49, v49
    v_lshlrev_b32 v48, 16, v48
    v_lshlrev_b32 v49, 16, v49
    s_waitcnt lgkmcnt(9)
    v_mfma_f32_16x16x32_bf16 v[32:35], v[152:155], v[236:239], v[32:35]
    v_rcp_f32 v49, v49
    v_mfma_f32_16x16x32_bf16 v[56:59], v[156:159], v[236:239], v[56:59]
    s_waitcnt lgkmcnt(7)
    v_mfma_f32_16x16x32_bf16 v[32:35], v[160:163], v[240:243], v[32:35]
    v_mfma_f32_16x16x32_bf16 v[56:59], v[164:167], v[240:243], v[56:59]
    s_waitcnt lgkmcnt(6)
    v_mfma_f32_16x16x32_bf16 v[32:35], v[168:171], v[244:247], v[32:35]
    v_mfma_f32_16x16x32_bf16 v[56:59], v[172:175], v[244:247], v[56:59]
    s_waitcnt lgkmcnt(1)
    v_mfma_f32_16x16x32_bf16 v[32:35], v[176:179], v[248:251], v[32:35]
    v_mfma_f32_16x16x32_bf16 v[56:59], v[180:183], v[248:251], v[56:59]
    s_waitcnt lgkmcnt(0)
    v_mfma_f32_16x16x32_bf16 v[32:35], v[184:187], v[252:255], v[32:35]
    v_mfma_f32_16x16x32_bf16 v[56:59], v[188:191], v[252:255], v[56:59]
    s_nop 6
    v_fma_f32 v40, -v48, v36, v32
    v_fma_f32 v41, -v48, v37, v33
    v_fma_f32 v42, -v48, v38, v34
    v_fma_f32 v43, -v48, v39, v35
    v_add_f32_dpp v40, v56, v40 row_ror:8 row_mask:0xf bank_mask:0xf
    v_add_f32_dpp v41, v57, v41 row_ror:8 row_mask:0xf bank_mask:0xf
    v_add_f32_dpp v42, v58, v42 row_ror:8 row_mask:0xf bank_mask:0xf
    v_add_f32_dpp v43, v59, v43 row_ror:8 row_mask:0xf bank_mask:0xf
    s_mov_b32 exec_lo, 0xff00ff
    s_mov_b32 exec_hi, 0xff00ff
    v_mul_f32 v40, v40, v49
    v_mul_f32 v41, v41, v49
    v_mul_f32 v42, v42, v49
    v_mul_f32 v43, v43, v49
    v_max_f32 v40, 0, v40
    v_max_f32 v41, 0, v41
    v_max_f32 v42, 0, v42
    v_max_f32 v43, 0, v43
    v_cvt_pk_bf16_f32 v44, v40, v41
    v_cvt_pk_bf16_f32 v45, v42, v43
    buffer_store_dwordx4 v[44:47], v28, s[36:39], s9 offen
    buffer_store_dwordx4 v[44:47], v28, s[36:39], s10 offen sc1
    s_branch L_done
L_attn:
    s_mov_b32 s6, s68
    s_mov_b32 m0, s64
    s_waitcnt vmcnt(7)
    buffer_load_dwordx4 v240, s[48:51], s63 offen offset:0 nt lds
    s_waitcnt vmcnt(7)
    buffer_load_dwordx4 v241, s[48:51], s63 offen offset:1024 nt lds
    s_waitcnt vmcnt(7)
    buffer_load_dwordx4 v242, s[48:51], s63 offen offset:2048 nt lds
    s_waitcnt vmcnt(7)
    buffer_load_dwordx4 v243, s[48:51], s63 offen offset:3072 nt lds
    s_add_u32 s63, s63, 4096
    s_add_u32 s64, s64, 4096
    s_mov_b32 m0, s64
    s_waitcnt vmcnt(7)
    buffer_load_dwordx4 v240, s[48:51], s63 offen offset:0 nt lds
    s_waitcnt vmcnt(7)
    buffer_load_dwordx4 v241, s[48:51], s63 offen offset:1024 nt lds
    s_waitcnt vmcnt(7)
    buffer_load_dwordx4 v242, s[48:51], s63 offen offset:2048 nt lds
    s_waitcnt vmcnt(7)
    buffer_load_dwordx4 v243, s[48:51], s63 offen offset:3072 nt lds
    s_add_u32 s63, s63, 4096
    s_add_u32 s64, s64, 4096
    s_mov_b32 s44, s20
    s_mov_b32 s45, s21
    s_mov_b32 s46, 33554432
    s_mov_b32 s47, 0x20000
    v_lshlrev_b32 v22, 1, v3
    v_xor_b32 v22, v2, v22
    v_lshlrev_b32 v22, 4, v22
    v_lshl_add_u32 v244, v3, 8, v22
    v_xor_b32 v245, 128, v244
    s_mov_b32 s63, s66
    s_add_u32 s64, s62, 0x10000
    s_lshr_b32 s10, s7, 2
    s_lshl_b32 s10, s10, 16
    s_lshl_b32 s11, s4, 9
    s_add_u32 s10, s10, s11
    s_add_u32 s58, s10, 1048576
    s_add_u32 s59, s58, 262144
    s_add_u32 s60, s58, 524288
    s_add_u32 s61, s58, 786432
    v_lshrrev_b32 v22, 4, v0
    v_lshlrev_b32 v22, 12, v22
    v_lshl_add_u32 v248, v2, 4, v22
    s_mov_b32 m0, s64
    s_waitcnt vmcnt(7)
    buffer_load_dwordx4 v244, s[44:47], s63 offen offset:0 nt lds
    s_waitcnt vmcnt(7)
    buffer_load_dwordx4 v245, s[44:47], s63 offen offset:1024 nt lds
    s_waitcnt vmcnt(7)
    buffer_load_dwordx4 v244, s[44:47], s63 offen offset:2048 nt lds
    s_waitcnt vmcnt(7)
    buffer_load_dwordx4 v245, s[44:47], s63 offen offset:3072 nt lds
    s_add_u32 s63, s63, 4096
    s_add_u32 s64, s64, 4096
    v_lshl_add_u32 v27, v25, 2, v23
    v_lshl_add_u32 v27, v27, 5, v24
    v_lshl_add_u32 v22, v3, 2, v23
    s_lshl_b32 s13, s3, 6
    v_xor_b32 v27, s13, v27
    v_lshl_add_u32 v247, v22, 8, v27
    v_add_u32 v247, 0x10000, v247
    v_xor_b32 v250, 32, v247
    v_xor_b32 v22, v3, v2
    v_lshlrev_b32 v22, 4, v22
    v_lshl_add_u32 v246, v2, 8, v22
    v_add_u32 v246, s62, v246
    v_mul_u32_u24 v22, 288, v16
    v_lshl_add_u32 v249, v17, 3, v22
    v_add_u32 v249, 135424, v249
    v_mul_u32_u24 v22, 288, v19
    v_lshl_add_u32 v8, v3, 4, v22
    v_add_u32 v8, 135424, v8
    v_lshlrev_b32 v22, 4, v19
    v_add_u32 v252, 141824, v22
    s_lshl_b32 s13, s3, 2
    v_add_u32 v251, s13, v252
    v_lshl_add_u32 v22, v3, 7, v22
    v_add_u32 v254, 137728, v22
    s_lshl_b32 s13, s3, 10
    v_add_u32 v253, s13, v254
    v_lshlrev_b32 v18, 4, v1
    s_lshl_b32 s13, s3, 1
    v_lshrrev_b32 v22, 3, v2
    v_add_u32 v22, s13, v22
    v_lshl_add_u32 v22, v22, 2, v3
    v_lshlrev_b32 v22, 4, v22
    v_lshl_add_u32 v255, v19, 9, v22
    v_cmp_lt_u32 s[66:67], 7, v2
    v_xor_b32 v37, 64, v246
    v_xor_b32 v38, 128, v246
    v_xor_b32 v39, 192, v246
    v_mov_b32 v59, s8
    v_mov_b32 v62, s8
    v_mov_b32 v63, s8
    v_mov_b32 v28, 0x3fb8aa3b
    v_mov_b32 v29, v28
    v_lshl_add_u32 v4, v20, 11, v21
    v_xor_b32 v5, 64, v4
    buffer_load_dwordx4 v[192:195], v248, s[36:39], s58 offen offset:0 sc1
    buffer_load_dwordx4 v[200:203], v248, s[36:39], s59 offen offset:0 sc1
    buffer_load_dwordx4 v[208:211], v248, s[36:39], s60 offen offset:0 sc1
    buffer_load_dwordx4 v[216:219], v248, s[36:39], s61 offen offset:0 sc1
    s_mov_b32 m0, s64
    s_waitcnt vmcnt(11)
    buffer_load_dwordx4 v244, s[44:47], s63 offen offset:0 nt lds
    s_waitcnt vmcnt(11)
    buffer_load_dwordx4 v245, s[44:47], s63 offen offset:1024 nt lds
    s_waitcnt vmcnt(11)
    buffer_load_dwordx4 v244, s[44:47], s63 offen offset:2048 nt lds
    s_waitcnt vmcnt(11)
    buffer_load_dwordx4 v245, s[44:47], s63 offen offset:3072 nt lds
    s_add_u32 s63, s63, 4096
    s_add_u32 s64, s64, 4096
    s_waitcnt vmcnt(12)
    ds_read_b128 v[64:67], v246 offset:0
    ds_read_b128 v[68:71], v37 offset:0
    ds_read_b128 v[72:75], v38 offset:0
    ds_read_b128 v[76:79], v39 offset:0
    ds_read_b128 v[80:83], v246 offset:4096
    ds_read_b128 v[84:87], v37 offset:4096
    ds_read_b128 v[88:91], v38 offset:4096
    ds_read_b128 v[92:95], v39 offset:4096
    ds_read_b128 v[96:99], v246 offset:8192
    ds_read_b128 v[100:103], v37 offset:8192
    ds_read_b128 v[104:107], v38 offset:8192
    ds_read_b128 v[108:111], v39 offset:8192
    ds_read_b128 v[112:115], v246 offset:12288
    ds_read_b128 v[116:119], v37 offset:12288
    ds_read_b128 v[120:123], v38 offset:12288
    ds_read_b128 v[124:127], v39 offset:12288
    s_mov_b32 s57, 0
    s_waitcnt vmcnt(4)
    v_xor_b32 v10, s8, v195
    v_bitop3_b32 v10, v10, v203, s8 bitop3:0xF6
    v_bitop3_b32 v10, v10, v211, s8 bitop3:0xF6
    v_bitop3_b32 v10, v10, v219, s8 bitop3:0xF6
    v_cmp_ne_u32 vcc, 0, v10
    s_cbranch_vccz L_ge_23
L_g_22:
    buffer_load_dwordx4 v[192:195], v248, s[36:39], s58 offen offset:0 sc1
    buffer_load_dwordx4 v[200:203], v248, s[36:39], s59 offen offset:0 sc1
    buffer_load_dwordx4 v[208:211], v248, s[36:39], s60 offen offset:0 sc1
    buffer_load_dwordx4 v[216:219], v248, s[36:39], s61 offen offset:0 sc1
    s_add_u32 s57, s57, 1
    s_waitcnt vmcnt(0)
    v_xor_b32 v10, s8, v195
    v_bitop3_b32 v10, v10, v203, s8 bitop3:0xF6
    v_bitop3_b32 v10, v10, v211, s8 bitop3:0xF6
    v_bitop3_b32 v10, v10, v219, s8 bitop3:0xF6
    v_cmp_ne_u32 vcc, 0, v10
    s_cbranch_vccz L_ge_23
    s_cmp_lt_u32 s57, 150000
    s_cbranch_scc1 L_g_22
L_ge_23:
    v_perm_b32 v195, v193, v192, s55
    v_perm_b32 v195, v194, v195, s56
    v_and_b32 v192, 0xffffff00, v192
    v_and_b32 v193, 0xffffff00, v193
    v_and_b32 v194, 0xffffff00, v194
    v_perm_b32 v203, v201, v200, s55
    v_perm_b32 v203, v202, v203, s56
    v_and_b32 v200, 0xffffff00, v200
    v_and_b32 v201, 0xffffff00, v201
    v_and_b32 v202, 0xffffff00, v202
    v_perm_b32 v211, v209, v208, s55
    v_perm_b32 v211, v210, v211, s56
    v_and_b32 v208, 0xffffff00, v208
    v_and_b32 v209, 0xffffff00, v209
    v_and_b32 v210, 0xffffff00, v210
    v_perm_b32 v219, v217, v216, s55
    v_perm_b32 v219, v218, v219, s56
    v_and_b32 v216, 0xffffff00, v216
    v_and_b32 v217, 0xffffff00, v217
    v_and_b32 v218, 0xffffff00, v218
    v_pk_add_f32 v[12:13], v[192:193], v[200:201]
    v_pk_add_f32 v[32:33], v[208:209], v[216:217]
    v_pk_add_f32 v[14:15], v[194:195], v[202:203]
    v_pk_add_f32 v[34:35], v[210:211], v[218:219]
    v_pk_add_f32 v[12:13], v[12:13], v[32:33]
    v_pk_add_f32 v[14:15], v[14:15], v[34:35]
    v_cvt_pk_bf16_f32 v12, v12, v13
    v_cvt_pk_bf16_f32 v13, v14, v15
    ds_write_b64 v249, v[12:13]
    s_mov_b32 m0, s64
    s_nop 0
    buffer_load_dwordx4 v244, s[44:47], s63 offen offset:0 nt lds
    s_mov_b32 m0, s64
    s_nop 0
    buffer_load_dwordx4 v245, s[44:47], s63 offen offset:1024 nt lds
    s_mov_b32 s9, 0x3db504f3
    s_mov_b32 s10, 0x3fb8aa3b
    s_waitcnt lgkmcnt(0)
    s_barrier
    ds_read_b128 v[192:195], v8 offset:0
    ds_read_b128 v[196:199], v8 offset:64
    ds_read_b128 v[200:203], v8 offset:128
    ds_read_b128 v[204:207], v8 offset:192
    s_mov_b32 m0, s64
    s_nop 0
    buffer_load_dwordx4 v244, s[44:47], s63 offen offset:2048 nt lds
    s_mov_b32 m0, s64
    s_nop 0
    buffer_load_dwordx4 v245, s[44:47], s63 offen offset:3072 nt lds
    s_add_u32 s63, s63, 4096
    s_add_u32 s64, s64, 4096
    s_waitcnt lgkmcnt(3)
    v_mfma_f32_16x16x32_bf16 v[32:35], v[64:67], v[192:195], 0
    v_mfma_f32_16x16x32_bf16 v[36:39], v[80:83], v[192:195], 0
    v_mfma_f32_16x16x32_bf16 v[40:43], v[96:99], v[192:195], 0
    v_mfma_f32_16x16x32_bf16 v[44:47], v[112:115], v[192:195], 0
    s_waitcnt lgkmcnt(2)
    v_mfma_f32_16x16x32_bf16 v[32:35], v[68:71], v[196:199], v[32:35]
    v_mfma_f32_16x16x32_bf16 v[36:39], v[84:87], v[196:199], v[36:39]
    v_mfma_f32_16x16x32_bf16 v[40:43], v[100:103], v[196:199], v[40:43]
    v_mfma_f32_16x16x32_bf16 v[44:47], v[116:119], v[196:199], v[44:47]
    s_waitcnt lgkmcnt(1)
    v_mfma_f32_16x16x32_bf16 v[32:35], v[72:75], v[200:203], v[32:35]
    v_mfma_f32_16x16x32_bf16 v[36:39], v[88:91], v[200:203], v[36:39]
    v_mfma_f32_16x16x32_bf16 v[40:43], v[104:107], v[200:203], v[40:43]
    v_mfma_f32_16x16x32_bf16 v[44:47], v[120:123], v[200:203], v[44:47]
    s_waitcnt lgkmcnt(0)
    v_mfma_f32_16x16x32_bf16 v[32:35], v[76:79], v[204:207], v[32:35]
    v_mfma_f32_16x16x32_bf16 v[36:39], v[92:95], v[204:207], v[36:39]
    v_mfma_f32_16x16x32_bf16 v[40:43], v[108:111], v[204:207], v[40:43]
    v_mfma_f32_16x16x32_bf16 v[44:47], v[124:127], v[204:207], v[44:47]
    s_nop 4
    v_cvt_pk_bf16_f32 v48, v32, v33
    v_cvt_pk_bf16_f32 v49, v34, v35
    v_cvt_pk_bf16_f32 v50, v36, v37
    v_cvt_pk_bf16_f32 v51, v38, v39
    v_cvt_pk_bf16_f32 v52, v40, v41
    v_cvt_pk_bf16_f32 v53, v42, v43
    v_cvt_pk_bf16_f32 v54, v44, v45
    v_cvt_pk_bf16_f32 v55, v46, v47
    v_lshlrev_b32 v64, 16, v48
    v_and_b32 v65, 0xffff0000, v48
    v_lshlrev_b32 v66, 16, v49
    v_and_b32 v67, 0xffff0000, v49
    v_lshlrev_b32 v68, 16, v50
    v_and_b32 v69, 0xffff0000, v50
    v_lshlrev_b32 v70, 16, v51
    v_and_b32 v71, 0xffff0000, v51
    v_lshlrev_b32 v72, 16, v52
    v_and_b32 v73, 0xffff0000, v52
    v_lshlrev_b32 v74, 16, v53
    v_and_b32 v75, 0xffff0000, v53
    v_lshlrev_b32 v76, 16, v54
    v_and_b32 v77, 0xffff0000, v54
    v_lshlrev_b32 v78, 16, v55
    v_and_b32 v79, 0xffff0000, v55
    s_mov_b32 m0, s64
    s_nop 0
    buffer_load_dwordx4 v244, s[44:47], s63 offen offset:0 nt lds
    s_mov_b32 m0, s64
    s_nop 0
    buffer_load_dwordx4 v245, s[44:47], s63 offen offset:1024 nt lds
    v_mul_f32 v64, s9, v64
    v_mul_f32 v65, s9, v65
    v_mul_f32 v66, s9, v66
    v_mul_f32 v67, s9, v67
    v_mul_f32 v68, s9, v68
    v_mul_f32 v69, s9, v69
    v_mul_f32 v70, s9, v70
    v_mul_f32 v71, s9, v71
    v_mul_f32 v72, s9, v72
    v_mul_f32 v73, s9, v73
    v_mul_f32 v74, s9, v74
    v_mul_f32 v75, s9, v75
    v_mul_f32 v76, s9, v76
    v_mul_f32 v77, s9, v77
    v_mul_f32 v78, s9, v78
    v_mul_f32 v79, s9, v79
    v_cvt_pk_bf16_f32 v48, v64, v65
    v_cvt_pk_bf16_f32 v49, v66, v67
    v_cvt_pk_bf16_f32 v50, v68, v69
    v_cvt_pk_bf16_f32 v51, v70, v71
    v_cvt_pk_bf16_f32 v52, v72, v73
    v_cvt_pk_bf16_f32 v53, v74, v75
    v_cvt_pk_bf16_f32 v54, v76, v77
    v_cvt_pk_bf16_f32 v55, v78, v79
    v_lshlrev_b32 v64, 16, v48
    v_and_b32 v65, 0xffff0000, v48
    v_lshlrev_b32 v66, 16, v49
    v_and_b32 v67, 0xffff0000, v49
    v_lshlrev_b32 v68, 16, v50
    v_and_b32 v69, 0xffff0000, v50
    v_lshlrev_b32 v70, 16, v51
    v_and_b32 v71, 0xffff0000, v51
    v_lshlrev_b32 v72, 16, v52
    v_and_b32 v73, 0xffff0000, v52
    v_lshlrev_b32 v74, 16, v53
    v_and_b32 v75, 0xffff0000, v53
    v_lshlrev_b32 v76, 16, v54
    v_and_b32 v77, 0xffff0000, v54
    v_lshlrev_b32 v78, 16, v55
    v_and_b32 v79, 0xffff0000, v55
    v_max3_f32 v32, v64, v65, v66
    v_max3_f32 v33, v67, v68, v69
    v_max3_f32 v34, v70, v71, v72
    v_max3_f32 v35, v73, v74, v75
    v_max3_f32 v36, v76, v77, v78
    v_max3_f32 v32, v32, v33, v79
    v_max3_f32 v34, v34, v35, v36
    v_max_f32 v30, v32, v34
    v_mov_b32 v11, v30
    s_nop 1
    v_permlane16_swap_b32 v30, v11
    s_nop 0
    v_max_f32 v30, v30, v11
    v_mov_b32 v11, v30
    s_nop 1
    v_permlane32_swap_b32 v30, v11
    s_nop 0
    v_max_f32 v30, v30, v11
    s_mov_b32 exec_lo, 0xff
    s_mov_b32 exec_hi, 0x0
    ds_write_b32 v251, v30
    s_mov_b64 exec, -1
    s_mov_b32 m0, s64
    s_nop 0
    buffer_load_dwordx4 v244, s[44:47], s63 offen offset:2048 nt lds
    s_mov_b32 m0, s64
    s_nop 0
    buffer_load_dwordx4 v245, s[44:47], s63 offen offset:3072 nt lds
    s_add_u32 s63, s63, 4096
    s_add_u32 s64, s64, 4096
    v_pk_mul_f32 v[64:65], v[64:65], v[28:29]
    v_pk_mul_f32 v[66:67], v[66:67], v[28:29]
    v_pk_mul_f32 v[68:69], v[68:69], v[28:29]
    v_pk_mul_f32 v[70:71], v[70:71], v[28:29]
    v_pk_mul_f32 v[72:73], v[72:73], v[28:29]
    v_pk_mul_f32 v[74:75], v[74:75], v[28:29]
    v_pk_mul_f32 v[76:77], v[76:77], v[28:29]
    v_pk_mul_f32 v[78:79], v[78:79], v[28:29]
    s_waitcnt lgkmcnt(0)
    s_barrier
    ds_read_b128 v[32:35], v252
    s_lshl_b32 s9, s6, 12
    s_add_u32 s9, s9, 2097152
    s_lshl_b32 s11, s6, 7
    s_add_u32 s11, s11, 2621440
    s_waitcnt lgkmcnt(0)
    v_max3_f32 v30, v32, v33, v34
    v_max_f32 v30, v30, v35
    v_mul_f32 v60, s10, v30
    v_sub_f32 v64, v64, v60
    v_sub_f32 v65, v65, v60
    v_sub_f32 v66, v66, v60
    v_sub_f32 v67, v67, v60
    v_sub_f32 v68, v68, v60
    v_sub_f32 v69, v69, v60
    v_sub_f32 v70, v70, v60
    v_sub_f32 v71, v71, v60
    v_sub_f32 v72, v72, v60
    v_sub_f32 v73, v73, v60
    v_sub_f32 v74, v74, v60
    v_sub_f32 v75, v75, v60
    v_sub_f32 v76, v76, v60
    v_sub_f32 v77, v77, v60
    v_sub_f32 v78, v78, v60
    v_sub_f32 v79, v79, v60
    v_exp_f32 v64, v64
    v_exp_f32 v65, v65
    v_exp_f32 v66, v66
    v_exp_f32 v67, v67
    v_exp_f32 v68, v68
    v_exp_f32 v69, v69
    v_exp_f32 v70, v70
    v_exp_f32 v71, v71
    v_exp_f32 v72, v72
    v_exp_f32 v73, v73
    v_exp_f32 v74, v74
    v_exp_f32 v75, v75
    v_exp_f32 v76, v76
    v_exp_f32 v77, v77
    v_exp_f32 v78, v78
    v_exp_f32 v79, v79
    v_cvt_pk_bf16_f32 v48, v64, v65
    v_cvt_pk_bf16_f32 v49, v66, v67
    v_cvt_pk_bf16_f32 v50, v68, v69
    v_cvt_pk_bf16_f32 v51, v70, v71
    v_cvt_pk_bf16_f32 v52, v72, v73
    v_cvt_pk_bf16_f32 v53, v74, v75
    v_cvt_pk_bf16_f32 v54, v76, v77
    v_cvt_pk_bf16_f32 v55, v78, v79
    s_mov_b32 exec_lo, 0xff00ff
    s_mov_b32 exec_hi, 0xff00ff
    ds_write_b128 v253, v[48:51]
    ds_write_b128 v253, v[52:55] offset:512
    s_mov_b64 exec, -1
    v_pk_add_f32 v[64:65], v[64:65], v[66:67]
    v_pk_add_f32 v[68:69], v[68:69], v[70:71]
    v_pk_add_f32 v[72:73], v[72:73], v[74:75]
    v_pk_add_f32 v[76:77], v[76:77], v[78:79]
    v_pk_add_f32 v[64:65], v[64:65], v[68:69]
    v_pk_add_f32 v[72:73], v[72:73], v[76:77]
    v_pk_add_f32 v[64:65], v[64:65], v[72:73]
    v_add_f32 v31, v64, v65
    v_mov_b32 v11, v31
    s_nop 1
    v_permlane16_swap_b32 v31, v11
    s_nop 0
    v_add_f32 v31, v31, v11
    v_mov_b32 v11, v31
    s_nop 1
    v_permlane32_swap_b32 v31, v11
    s_nop 0
    v_add_f32 v31, v31, v11
    s_mov_b32 exec_lo, 0xff
    s_mov_b32 exec_hi, 0x0
    ds_write_b32 v251, v31 offset:128
    s_mov_b64 exec, -1
    s_mov_b32 s48, s30
    s_mov_b32 s49, s31
    s_mov_b32 s50, 7340032
    s_mov_b32 s51, 0x20000
    s_lshl_b32 s12, s4, 2
    s_add_u32 s12, s12, s3
    s_mul_i32 s12, s12, 229376
    s_lshl_b32 s13, s7, 7
    s_add_u32 s63, s12, s13
    s_mul_i32 s64, s3, 14336
    s_waitcnt vmcnt(8) lgkmcnt(0)
    s_barrier
    ds_read_b128 v[192:195], v254 offset:0
    ds_read_b64_tr_b16 v[128:129], v247 offset:0
    ds_read_b64_tr_b16 v[130:131], v247 offset:4096
    ds_read_b64_tr_b16 v[132:133], v250 offset:0
    ds_read_b64_tr_b16 v[134:135], v250 offset:4096
    ds_read_b128 v[200:203], v254 offset:1024
    ds_read_b64_tr_b16 v[136:137], v247 offset:16384
    ds_read_b64_tr_b16 v[138:139], v247 offset:20480
    ds_read_b64_tr_b16 v[140:141], v250 offset:16384
    ds_read_b64_tr_b16 v[142:143], v250 offset:20480
    ds_read_b128 v[208:211], v254 offset:2048
    ds_read_b64_tr_b16 v[144:145], v247 offset:32768
    ds_read_b64_tr_b16 v[146:147], v247 offset:36864
    ds_read_b64_tr_b16 v[148:149], v250 offset:32768
    ds_read_b64_tr_b16 v[150:151], v250 offset:36864
    ds_read_b128 v[216:219], v254 offset:3072
    ds_read_b64_tr_b16 v[152:153], v247 offset:49152
    ds_read_b64_tr_b16 v[154:155], v247 offset:53248
    ds_read_b64_tr_b16 v[156:157], v250 offset:49152
    ds_read_b64_tr_b16 v[158:159], v250 offset:53248
    s_waitcnt lgkmcnt(15)
    v_mfma_f32_16x16x32_bf16 v[224:227], v[128:131], v[192:195], 0
    v_mfma_f32_16x16x32_bf16 v[228:231], v[132:135], v[192:195], 0
    s_waitcnt lgkmcnt(10)
    v_mfma_f32_16x16x32_bf16 v[224:227], v[136:139], v[200:203], v[224:227]
    v_mfma_f32_16x16x32_bf16 v[228:231], v[140:143], v[200:203], v[228:231]
    s_waitcnt lgkmcnt(5)
    v_mfma_f32_16x16x32_bf16 v[224:227], v[144:147], v[208:211], v[224:227]
    v_mfma_f32_16x16x32_bf16 v[228:231], v[148:151], v[208:211], v[228:231]
    s_waitcnt lgkmcnt(0)
    v_mfma_f32_16x16x32_bf16 v[224:227], v[152:155], v[216:219], v[224:227]
    v_mfma_f32_16x16x32_bf16 v[228:231], v[156:159], v[216:219], v[228:231]
    ds_read_b128 v[196:199], v254 offset:512
    ds_read_b128 v[204:207], v254 offset:1536
    ds_read_b128 v[212:215], v254 offset:2560
    ds_read_b128 v[220:223], v254 offset:3584
    ds_read_b128 v[32:35], v252 offset:128
    s_waitcnt vmcnt(0)
    s_barrier
    ds_read_b64_tr_b16 v[160:161], v247 offset:8192
    ds_read_b64_tr_b16 v[162:163], v247 offset:12288
    ds_read_b64_tr_b16 v[164:165], v250 offset:8192
    ds_read_b64_tr_b16 v[166:167], v250 offset:12288
    ds_read_b64_tr_b16 v[168:169], v247 offset:24576
    ds_read_b64_tr_b16 v[170:171], v247 offset:28672
    ds_read_b64_tr_b16 v[172:173], v250 offset:24576
    ds_read_b64_tr_b16 v[174:175], v250 offset:28672
    ds_read_b64_tr_b16 v[176:177], v247 offset:40960
    ds_read_b64_tr_b16 v[178:179], v247 offset:45056
    ds_read_b64_tr_b16 v[180:181], v250 offset:40960
    ds_read_b64_tr_b16 v[182:183], v250 offset:45056
    ds_read_b64_tr_b16 v[184:185], v247 offset:57344
    ds_read_b64_tr_b16 v[186:187], v247 offset:61440
    ds_read_b64_tr_b16 v[188:189], v250 offset:57344
    ds_read_b64_tr_b16 v[190:191], v250 offset:61440
    s_waitcnt lgkmcnt(12)
    v_mfma_f32_16x16x32_bf16 v[224:227], v[160:163], v[196:199], v[224:227]
    v_mfma_f32_16x16x32_bf16 v[228:231], v[164:167], v[196:199], v[228:231]
    v_pk_add_f32 v[32:33], v[32:33], v[34:35]
    s_waitcnt lgkmcnt(8)
    v_mfma_f32_16x16x32_bf16 v[224:227], v[168:171], v[204:207], v[224:227]
    v_mfma_f32_16x16x32_bf16 v[228:231], v[172:175], v[204:207], v[228:231]
    v_add_f32 v61, v32, v33
    s_waitcnt lgkmcnt(4)
    v_mfma_f32_16x16x32_bf16 v[224:227], v[176:179], v[212:215], v[224:227]
    v_mfma_f32_16x16x32_bf16 v[228:231], v[180:183], v[212:215], v[228:231]
    s_waitcnt lgkmcnt(0)
    v_mfma_f32_16x16x32_bf16 v[224:227], v[184:187], v[220:223], v[224:227]
    v_mfma_f32_16x16x32_bf16 v[228:231], v[188:191], v[220:223], v[228:231]
    s_cmp_lg_u32 s3, 0
    s_cbranch_scc1 L_nst
    s_mov_b32 exec_lo, 0xff
    s_mov_b32 exec_hi, 0x0
    buffer_store_dwordx4 v[60:63], v18, s[36:39], s11 offen sc1
    s_mov_b64 exec, -1
L_nst:
    s_nop 5
    v_cndmask_b32 v40, v224, v228, s[66:67]
    v_cndmask_b32 v41, v225, v229, s[66:67]
    v_cndmask_b32 v42, v226, v230, s[66:67]
    v_cndmask_b32 v43, v227, v231, s[66:67]
    v_perm_b32 v56, v40, v43, s52
    v_perm_b32 v57, v41, v43, s53
    v_perm_b32 v58, v42, v43, s54
    buffer_store_dwordx4 v[56:59], v255, s[36:39], s9 offen sc1
    s_cmp_lg_u32 s3, 0
    s_cbranch_scc1 L_hp_24
    s_lshl_b32 s15, s4, 4
    s_add_u32 s15, s15, s7
    s_lshl_b32 s15, s15, 4
    s_add_u32 s15, s15, 3014656
    v_mov_b32 v12, 0
    s_mov_b64 exec, 1
    buffer_store_dword v63, v12, s[36:39], s15 offen
    s_mov_b64 exec, -1
L_hp_24:
    s_mov_b32 m0, s64
    s_waitcnt vmcnt(0)
    buffer_load_dwordx4 v4, s[48:51], s63 offen offset:0 nt lds
    s_waitcnt vmcnt(0)
    s_add_u32 s15, s63, 15360
    buffer_load_dwordx4 v5, s[48:51], s15 offen offset:1024 nt lds
    s_waitcnt vmcnt(0)
    s_add_u32 s15, s63, 30720
    buffer_load_dwordx4 v4, s[48:51], s15 offen offset:2048 nt lds
    s_waitcnt vmcnt(0)
    s_add_u32 s15, s63, 46080
    buffer_load_dwordx4 v5, s[48:51], s15 offen offset:3072 nt lds
    s_add_u32 s63, s63, 65536
    s_add_u32 s64, s64, 4096
    s_mov_b32 m0, s64
    s_nop 0
    buffer_load_dwordx4 v4, s[48:51], s63 offen offset:0 nt lds
    s_add_u32 s15, s63, 15360
    buffer_load_dwordx4 v5, s[48:51], s15 offen offset:1024 nt lds
    s_add_u32 s15, s63, 30720
    buffer_load_dwordx4 v4, s[48:51], s15 offen offset:2048 nt lds
    s_add_u32 s15, s63, 46080
    buffer_load_dwordx4 v5, s[48:51], s15 offen offset:3072 nt lds
    s_add_u32 s63, s63, 65536
    s_add_u32 s64, s64, 4096
    s_mov_b32 m0, s64
    s_nop 0
    buffer_load_dwordx4 v4, s[48:51], s63 offen offset:0 nt lds
    s_add_u32 s15, s63, 15360
    buffer_load_dwordx4 v5, s[48:51], s15 offen offset:1024 nt lds
    s_add_u32 s15, s63, 30720
    buffer_load_dwordx4 v4, s[48:51], s15 offen offset:2048 nt lds
    s_add_u32 s15, s63, 46080
    buffer_load_dwordx4 v5, s[48:51], s15 offen offset:3072 nt lds
    s_add_u32 s63, s63, 65536
    s_add_u32 s64, s64, 4096
    s_mov_b32 m0, s64
    s_nop 0
    buffer_load_dwordx4 v4, s[48:51], s63 offen offset:0 nt lds
    s_add_u32 s15, s63, 15360
    buffer_load_dwordx4 v5, s[48:51], s15 offen offset:1024 nt lds
    s_add_u32 s63, s63, 65536
    s_add_u32 s64, s64, 4096
    v_mul_u32_u24 v22, 928, v19
    v_add_u32 v22, 137728, v22
    v_lshrrev_b32 v27, 3, v0
    v_lshl_add_u32 v29, v27, 3, v22
    v_lshl_add_u32 v8, v3, 4, v22
    v_and_b32 v22, 8, v1
    v_lshl_add_u32 v8, v22, 3, v8
    s_lshl_b32 s13, s3, 12
    v_lshlrev_b32 v22, 10, v3
    v_lshl_add_u32 v28, v2, 4, v22
    v_add_u32 v28, s13, v28
    s_mul_i32 s58, s4, 14336
    s_add_u32 s58, s58, 3407872
    s_add_u32 s59, s58, 4096
    s_add_u32 s60, s58, 8192
    s_add_u32 s61, s58, 12288
    s_cmp_ge_u32 s3, 2
    s_cselect_b32 s61, s58, s61
    s_lshl_b32 s9, s7, 14
    s_lshl_b32 s10, s4, 7
    s_add_u32 s9, s9, s10
    s_add_u32 s9, s9, 3670016
    v_mov_b32 v47, s8
    s_waitcnt vmcnt(0)
    s_barrier
    ds_read_b64_tr_b16 v[64:65], v6 offset:0
    ds_read_b64_tr_b16 v[66:67], v6 offset:512
    ds_read_b64_tr_b16 v[68:69], v6 offset:4096
    ds_read_b64_tr_b16 v[70:71], v6 offset:4608
    ds_read_b64_tr_b16 v[72:73], v6 offset:8192
    ds_read_b64_tr_b16 v[74:75], v6 offset:8704
    ds_read_b64_tr_b16 v[76:77], v6 offset:12288
    ds_read_b64_tr_b16 v[78:79], v6 offset:12800
    ds_read_b64_tr_b16 v[80:81], v6 offset:16384
    ds_read_b64_tr_b16 v[82:83], v6 offset:16896
    ds_read_b64_tr_b16 v[84:85], v6 offset:20480
    ds_read_b64_tr_b16 v[86:87], v6 offset:20992
    ds_read_b64_tr_b16 v[88:89], v6 offset:24576
    ds_read_b64_tr_b16 v[90:91], v6 offset:25088
    ds_read_b64_tr_b16 v[92:93], v6 offset:28672
    ds_read_b64_tr_b16 v[94:95], v6 offset:29184
    ds_read_b64_tr_b16 v[96:97], v6 offset:32768
    ds_read_b64_tr_b16 v[98:99], v6 offset:33280
    ds_read_b64_tr_b16 v[100:101], v6 offset:36864
    ds_read_b64_tr_b16 v[102:103], v6 offset:37376
    ds_read_b64_tr_b16 v[104:105], v6 offset:40960
    ds_read_b64_tr_b16 v[106:107], v6 offset:41472
    ds_read_b64_tr_b16 v[108:109], v6 offset:45056
    ds_read_b64_tr_b16 v[110:111], v6 offset:45568
    ds_read_b64_tr_b16 v[112:113], v6 offset:49152
    ds_read_b64_tr_b16 v[114:115], v6 offset:49664
    ds_read_b64_tr_b16 v[116:117], v6 offset:53248
    ds_read_b64_tr_b16 v[118:119], v6 offset:53760
    buffer_load_dwordx4 v[192:195], v9, s[36:39], s58 offen sc1
    buffer_load_dwordx4 v[196:199], v9, s[36:39], s59 offen sc1
    buffer_load_dwordx4 v[200:203], v9, s[36:39], s60 offen sc1
    buffer_load_dwordx4 v[204:207], v9, s[36:39], s61 offen sc1
    s_mov_b32 s57, 0
    s_waitcnt vmcnt(0)
    v_xor_b32 v10, s8, v194
    v_bitop3_b32 v10, v10, v198, s8 bitop3:0xF6
    v_bitop3_b32 v10, v10, v202, s8 bitop3:0xF6
    v_bitop3_b32 v10, v10, v206, s8 bitop3:0xF6
    v_bitop3_b32 v10, v10, v195, s8 bitop3:0xF6
    v_bitop3_b32 v10, v10, v199, s8 bitop3:0xF6
    v_bitop3_b32 v10, v10, v203, s8 bitop3:0xF6
    v_bitop3_b32 v10, v10, v207, s8 bitop3:0xF6
    v_cmp_ne_u32 vcc, 0, v10
    s_cbranch_vccz L_ge_26
L_g_25:
    s_sleep 1
    buffer_load_dwordx4 v[192:195], v9, s[36:39], s58 offen sc1
    buffer_load_dwordx4 v[196:199], v9, s[36:39], s59 offen sc1
    buffer_load_dwordx4 v[200:203], v9, s[36:39], s60 offen sc1
    buffer_load_dwordx4 v[204:207], v9, s[36:39], s61 offen sc1
    s_add_u32 s57, s57, 1
    s_waitcnt vmcnt(0)
    v_xor_b32 v10, s8, v194
    v_bitop3_b32 v10, v10, v198, s8 bitop3:0xF6
    v_bitop3_b32 v10, v10, v202, s8 bitop3:0xF6
    v_bitop3_b32 v10, v10, v206, s8 bitop3:0xF6
    v_bitop3_b32 v10, v10, v195, s8 bitop3:0xF6
    v_bitop3_b32 v10, v10, v199, s8 bitop3:0xF6
    v_bitop3_b32 v10, v10, v203, s8 bitop3:0xF6
    v_bitop3_b32 v10, v10, v207, s8 bitop3:0xF6
    v_cmp_ne_u32 vcc, 0, v10
    s_cbranch_vccz L_ge_26
    s_cmp_lt_u32 s57, 300
    s_cbranch_scc1 L_gl_27
    s_xor_b32 s58, s58, 4194304
    s_xor_b32 s59, s59, 4194304
    s_xor_b32 s60, s60, 4194304
    s_xor_b32 s61, s61, 4194304
L_gl_27:
    s_cmp_lt_u32 s57, 150000
    s_cbranch_scc1 L_g_25
L_ge_26:
    ds_write_b64 v29, v[192:193] offset:0
    ds_write_b64 v29, v[196:197] offset:256
    ds_write_b64 v29, v[200:201] offset:512
    s_cmp_ge_u32 s3, 2
    s_cbranch_scc1 L_a3
    ds_write_b64 v29, v[204:205] offset:768
L_a3:
    s_waitcnt lgkmcnt(0)
    s_barrier
    ds_read_b128 v[128:131], v8 offset:0
    ds_read_b128 v[132:135], v8 offset:128
    ds_read_b128 v[136:139], v8 offset:256
    ds_read_b128 v[140:143], v8 offset:384
    ds_read_b128 v[144:147], v8 offset:512
    ds_read_b128 v[148:151], v8 offset:640
    ds_read_b128 v[152:155], v8 offset:768
    s_waitcnt lgkmcnt(6)
    v_mfma_f32_16x16x32_bf16 v[32:35], v[64:67], v[128:131], 0
    v_mfma_f32_16x16x32_bf16 v[36:39], v[68:71], v[128:131], 0
    s_waitcnt lgkmcnt(5)
    v_mfma_f32_16x16x32_bf16 v[32:35], v[72:75], v[132:135], v[32:35]
    v_mfma_f32_16x16x32_bf16 v[36:39], v[76:79], v[132:135], v[36:39]
    s_waitcnt lgkmcnt(4)
    v_mfma_f32_16x16x32_bf16 v[32:35], v[80:83], v[136:139], v[32:35]
    v_mfma_f32_16x16x32_bf16 v[36:39], v[84:87], v[136:139], v[36:39]
    s_waitcnt lgkmcnt(3)
    v_mfma_f32_16x16x32_bf16 v[32:35], v[88:91], v[140:143], v[32:35]
    v_mfma_f32_16x16x32_bf16 v[36:39], v[92:95], v[140:143], v[36:39]
    s_waitcnt lgkmcnt(2)
    v_mfma_f32_16x16x32_bf16 v[32:35], v[96:99], v[144:147], v[32:35]
    v_mfma_f32_16x16x32_bf16 v[36:39], v[100:103], v[144:147], v[36:39]
    s_waitcnt lgkmcnt(1)
    v_mfma_f32_16x16x32_bf16 v[32:35], v[104:107], v[148:151], v[32:35]
    v_mfma_f32_16x16x32_bf16 v[36:39], v[108:111], v[148:151], v[36:39]
    s_waitcnt lgkmcnt(0)
    v_mfma_f32_16x16x32_bf16 v[32:35], v[112:115], v[152:155], v[32:35]
    v_mfma_f32_16x16x32_bf16 v[36:39], v[116:119], v[152:155], v[36:39]
    s_nop 7
    v_add_f32_dpp v32, v36, v32 row_ror:8 row_mask:0xf bank_mask:0xf
    v_add_f32_dpp v33, v37, v33 row_ror:8 row_mask:0xf bank_mask:0xf
    v_add_f32_dpp v34, v38, v34 row_ror:8 row_mask:0xf bank_mask:0xf
    v_add_f32_dpp v35, v39, v35 row_ror:8 row_mask:0xf bank_mask:0xf
    s_mov_b32 exec_lo, 0xff00ff
    s_mov_b32 exec_hi, 0xff00ff
    v_perm_b32 v44, v32, v35, s52
    v_perm_b32 v45, v33, v35, s53
    v_perm_b32 v46, v34, v35, s54
    buffer_store_dwordx4 v[44:47], v28, s[36:39], s9 offen sc1
    s_mov_b64 exec, -1
    s_cmp_lg_u32 s3, 0
    s_cbranch_scc1 L_hp_28
    s_lshl_b32 s15, s4, 4
    s_add_u32 s15, s15, s7
    s_lshl_b32 s15, s15, 4
    s_add_u32 s15, s15, 3018752
    v_mov_b32 v12, 0
    s_mov_b64 exec, 1
    buffer_store_dword v47, v12, s[36:39], s15 offen
    s_mov_b64 exec, -1
L_hp_28:
L_done:
L_end:
    s_endpgm
.section .rodata,"a"
.p2align 6
.amdhsa_kernel sequential_preLN__sliding_block_cached__dense_activation_relu__decode_kernel
  .amdhsa_next_free_vgpr 256
  .amdhsa_next_free_sgpr 102
  .amdhsa_accum_offset 256
  .amdhsa_group_segment_fixed_size 0
  .amdhsa_kernarg_size 88
  .amdhsa_user_sgpr_count 2
  .amdhsa_user_sgpr_kernarg_segment_ptr 1
  .amdhsa_system_sgpr_workgroup_id_x 1
.end_amdhsa_kernel
```
